```python
import torch

def _softmax(x, axis=-1):
    return torch.softmax(x, dim=axis)
def _gelu(x):
    return torch.nn.functional.gelu(x, approximate="tanh")
def _silu(x):
    return torch.nn.functional.silu(x)
def _sigmoid(x):
    return torch.sigmoid(x)
def _layernorm(x, axis=-1, eps=1e-5):
    m = x.mean(dim=axis, keepdim=True)
    v = x.var(dim=axis, keepdim=True, unbiased=False)
    return (x - m) / torch.sqrt(v + eps)
def _scatter_add(tgt, idx, src, axis=0):
    return tgt.clone().index_add_(axis, idx, src)
def _segment_sum(src, seg, n):
    out = torch.zeros((n,) + src.shape[1:], dtype=src.dtype)
    return out.index_add_(0, seg, src)
def _pad(x, pw):
    flat = tuple(v for pair in reversed(pw) for v in pair)
    return torch.nn.functional.pad(x, flat)

kernel_name = 'standalone__channel_attn_cbam__vision'

def setup_inputs():

    _w = (lambda a: (lambda t: t.to(torch.bfloat16) if t.is_floating_point() else t)(torch.as_tensor(a)))
    H = W = 512
    C = 192
    r = max(C // 4, 1)
    return {
        "x": _w((lambda *s: torch.randn(*s, dtype=torch.bfloat16) * 0.2)(1, H, W, C) + (lambda *s: torch.randn(*s, dtype=torch.bfloat16) * 0.2)(1, 1, 1, C) * 2.0),
        "w1": _w((lambda *s: torch.randn(*s, dtype=torch.bfloat16) * 0.2)(C, r)),
        "w2": _w((lambda *s: torch.randn(*s, dtype=torch.bfloat16) * 0.2)(r, C)),
    }

def reference(x, w1, w2):
    B, H, W, C = x.shape
    xf = x.reshape(B, H * W, C)
    gap = torch.mean(xf, 1)
    gmp = torch.amax(xf, 1)
    h_a = gap @ w1
    h_a = h_a * (lambda x, dt: x.to(dt))(h_a > 0, h_a.dtype)
    h_m = gmp @ w1
    h_m = h_m * (lambda x, dt: x.to(dt))(h_m > 0, h_m.dtype)
    scale = _sigmoid(h_a @ w2 + h_m @ w2)
    return x * scale[:, None, None, :]
```

```asm
; @launch grid=(256,1,1) block=(768,1,1) lds=64576
.amdgcn_target "amdgcn-amd-amdhsa--gfx950"
.text
.globl standalone__channel_attn_cbam__vision_kernel
.p2align 12
.p2align 8
.type standalone__channel_attn_cbam__vision_kernel,@function
standalone__channel_attn_cbam__vision_kernel:
    s_load_dwordx4 s[4:7], s[0:1], 0
    s_load_dwordx4 s[24:27], s[0:1], 16
    s_load_dwordx4 s[28:31], s[0:1], 32
    s_memtime s[58:59]
    s_cmp_ge_u32 s2, 256
    s_cbranch_scc1 L_end
    v_lshrrev_b32 v2, 6, v0
    v_and_b32 v35, 63, v0
    v_readfirstlane_b32 s36, v2
    s_mov_b32 s35, 0x20000
    s_lshr_b32 s40, s2, 2
    s_and_b32 s42, s2, 1
    s_or_b32 s40, s40, s42
    s_and_b32 s42, s2, 6
    s_cselect_b32 s40, 25, s40
    s_lshl_b32 s42, s36, 5
    s_or_b32 s42, s42, s40
    s_cmp_lt_u32 s42, 25
    s_cbranch_scc0 L_main
    s_getreg_b32 s48, hwreg(HW_REG_XCC_ID, 0, 3)
    s_mov_b64 exec, 1
    v_mov_b32 v2, 0
    s_mov_b32 s34, 100663296
    s_lshr_b32 s43, s40, 1
    s_and_b32 s55, s40, 1
    s_lshl_b32 s54, s55, 7
    s_cmp_eq_u32 s43, 12
    s_cselect_b32 s55, 2, s55
    s_cselect_b32 s42, 0, s43
    s_lshl_b32 s42, s42, 23
    s_bitset1_b32 s42, 22
    s_lshl_b32 s52, s48, 29
    s_cmp_eq_u32 s40, 0
    s_cselect_b32 s52, s52, 0
    s_bitset1_b32 s52, s43
    s_lshl_b32 s3, 0x10000, s43
    s_cmp_ge_u32 s48, 4
    s_cselect_b32 s48, s3, 0
    s_xor_b32 s3, s3, s48
    s_or_b32 s48, s48, s52
    s_or_b32 s3, s3, s52
    s_cmp_lt_u32 s40, 2
    s_cselect_b32 s52, s54, 0x1000
    v_mov_b32 v5, s52
    s_cmp_eq_u32 s55, 1
    s_waitcnt lgkmcnt(0)
    s_cselect_b32 s32, s26, s4
    s_cselect_b32 s33, s27, s5
    s_cmp_eq_u32 s55, 2
    s_cselect_b32 s32, s30, s32
    s_cselect_b32 s33, s31, s33
    s_lshl_b32 s43, s58, 5
    s_and_b32 s43, s43, 0x1fdf80
    s_add_u32 s42, s42, s43
    s_and_b32 s43, s32, 0x1ffffc
    s_sub_u32 s42, s42, s43
    s_add_u32 s43, s42, 8192
    s_mov_b32 s16, s28
    s_mov_b32 s17, s29
    s_mov_b32 s18, 256
    s_mov_b32 s19, 0x20000
    buffer_load_dword v3, v2, s[32:35], s42 offen nt
    buffer_load_dword v4, v2, s[32:35], s43 offen nt
    buffer_atomic_or v2, v5, s[16:19], 0 offen sc1
    s_waitcnt vmcnt(2)
    s_memtime s[56:57]
    s_waitcnt vmcnt(1)
    s_memtime s[58:59]
    s_waitcnt lgkmcnt(0)
    s_sub_u32 s42, s58, s56
    s_cmpk_le_u32 s42, 70
    s_cselect_b32 s48, s3, s48
    v_mov_b32 v15, s48
    buffer_atomic_or v15, v2, s[16:19], s54 offen sc1
    s_barrier
    s_cmp_lg_u32 s40, 0
    s_cbranch_scc1 L_notag
    s_memrealtime s[56:57]
    v_mov_b32 v12, 1
    s_waitcnt lgkmcnt(0)
    s_mul_i32 s43, s56, 0x9e3779b1
    v_mov_b32 v13, s43
    buffer_store_dwordx2 v[12:13], v2, s[16:19], 0 offen offset:192 sc1
L_notag:
    s_mov_b64 exec, -1
    s_mov_b32 s40, 25
L_main:
    s_lshr_b32 s42, s2, 4
    s_and_b32 s43, s36, 12
    s_lshl_b32 s43, s43, 4
    s_or_b32 s42, s42, s43
    s_cmp_lg_u32 s42, 7
    s_cbranch_scc1 L_nocode
    s_getpc_b64 s[54:55]
L_pc:
    v_lshlrev_b32 v32, 7, v0
    v_min_u32 v32, L_end-L_pc, v32
    v_add_co_u32 v32, vcc, s54, v32
    v_mov_b32 v33, s55
    s_nop 0
    v_addc_co_u32 v33, vcc, 0, v33, vcc
    global_load_dword v32, v[32:33], off
L_nocode:
    s_mul_i32 s37, s36, 43691
    s_lshr_b32 s37, s37, 17
    s_mul_i32 s38, s37, 3
    s_sub_u32 s38, s36, s38
    s_mul_i32 s39, s37, 3072
    s_lshl_b32 s42, s38, 7
    s_add_u32 s39, s39, s42
    v_lshrrev_b32 v0, 3, v35
    v_mul_u32_u24 v0, 384, v0
    v_and_b32 v1, 7, v35
    v_lshl_add_u32 v0, v1, 4, v0
    v_add_u32 v0, s39, v0
    v_add_u32 v1, 12288, v0
    s_lshr_b32 s42, s2, 3
    s_and_b32 s43, s2, 3
    s_lshl_b32 s51, s42, 2
    s_add_u32 s51, s51, s43
    s_mul_i32 s80, s51, 49152
    s_lshl_b32 s50, s2, 11
    s_lshl_b32 s42, s42, 13
    s_xor_b32 s50, s50, s42
    s_and_b32 s50, s50, 0x2000
    s_movk_i32 s49, 24576
    v_add_u32 v38, s50, v0
    v_bfe_u32 v38, v38, 13, 1
    v_mad_u32_u24 v38, v38, s49, v0
    v_add_u32 v39, s50, v1
    v_bfe_u32 v39, v39, 13, 1
    v_mad_u32_u24 v39, v39, s49, v1
    s_mov_b32 s10, 100663296
    s_mov_b32 s11, 0x20000
    s_cmp_lt_u32 s40, 25
    s_waitcnt lgkmcnt(0)
    s_mov_b32 s8, s4
    s_mov_b32 s9, s5
    s_cbranch_scc0 L_go
    s_barrier
L_go:
    buffer_load_dwordx4 v[40:43], v38, s[8:11], s80 offen nt
    s_add_u32 s81, s80, 6291456
    buffer_load_dwordx4 v[44:47], v39, s[8:11], s80 offen nt
    buffer_load_dwordx4 v[48:51], v38, s[8:11], s81 offen nt
    s_add_u32 s82, s81, 6291456
    buffer_load_dwordx4 v[52:55], v39, s[8:11], s81 offen nt
    s_add_u32 s20, s30, 0x400000
    s_addc_u32 s21, s31, 0
    s_and_b32 s20, s20, 0xffe00000
    s_mov_b32 s22, 0x100000
    s_mov_b32 s23, 0x20000
    s_mov_b32 s16, s28
    s_mov_b32 s17, s29
    s_mov_b32 s18, 256
    s_mov_b32 s19, 0x20000
    s_mov_b32 s12, s26
    s_mov_b32 s13, s27
    s_mov_b32 s14, 100663296
    s_mov_b32 s15, 0x20000
    s_mov_b32 s45, 0
    v_mov_b32 v34, s50
    v_lshlrev_b32 v36, 4, v35
    v_mov_b32 v2, 0
    v_mov_b32 v10, 0xff800000
    v_mov_b32 v3, 0
    v_mov_b32 v11, 0xff800000
    v_mov_b32 v4, 0
    v_mov_b32 v12, 0xff800000
    v_mov_b32 v5, 0
    v_mov_b32 v13, 0xff800000
    v_mov_b32 v6, 0
    v_mov_b32 v14, 0xff800000
    v_mov_b32 v7, 0
    v_mov_b32 v15, 0xff800000
    v_mov_b32 v8, 0
    v_mov_b32 v16, 0xff800000
    v_mov_b32 v9, 0
    v_mov_b32 v17, 0xff800000
    s_mov_b32 s44, 0xffff0000
    ds_write_b64 v2, v[2:3] offset:46080
    s_waitcnt vmcnt(2)
    buffer_load_dwordx4 v[56:59], v38, s[8:11], s82 offen nt
    s_add_u32 s83, s82, 6291456
    buffer_load_dwordx4 v[60:63], v39, s[8:11], s82 offen nt
    v_lshlrev_b32 v18, 16, v40
    v_and_b32 v19, s44, v40
    v_lshlrev_b32 v20, 16, v41
    v_and_b32 v21, s44, v41
    v_lshlrev_b32 v22, 16, v42
    v_and_b32 v23, s44, v42
    v_lshlrev_b32 v24, 16, v43
    v_and_b32 v25, s44, v43
    v_lshlrev_b32 v26, 16, v44
    v_and_b32 v27, s44, v44
    v_lshlrev_b32 v28, 16, v45
    v_and_b32 v29, s44, v45
    v_lshlrev_b32 v30, 16, v46
    v_and_b32 v31, s44, v46
    v_lshlrev_b32 v32, 16, v47
    v_and_b32 v33, s44, v47
    v_pk_add_f32 v[2:3], v[2:3], v[18:19]
    v_pk_add_f32 v[4:5], v[4:5], v[20:21]
    v_pk_add_f32 v[6:7], v[6:7], v[22:23]
    v_pk_add_f32 v[8:9], v[8:9], v[24:25]
    v_pk_add_f32 v[2:3], v[2:3], v[26:27]
    v_pk_add_f32 v[4:5], v[4:5], v[28:29]
    v_pk_add_f32 v[6:7], v[6:7], v[30:31]
    v_pk_add_f32 v[8:9], v[8:9], v[32:33]
    v_max3_f32 v10, v10, v18, v26
    v_max3_f32 v11, v11, v19, v27
    v_max3_f32 v12, v12, v20, v28
    v_max3_f32 v13, v13, v21, v29
    v_max3_f32 v14, v14, v22, v30
    v_max3_f32 v15, v15, v23, v31
    v_max3_f32 v16, v16, v24, v32
    v_max3_f32 v17, v17, v25, v33
    s_waitcnt vmcnt(2)
    buffer_load_dwordx4 v[64:67], v38, s[8:11], s83 offen nt
    s_add_u32 s84, s83, 6291456
    buffer_load_dwordx4 v[68:71], v39, s[8:11], s83 offen nt
    v_lshlrev_b32 v18, 16, v48
    v_and_b32 v19, s44, v48
    v_lshlrev_b32 v20, 16, v49
    v_and_b32 v21, s44, v49
    v_lshlrev_b32 v22, 16, v50
    v_and_b32 v23, s44, v50
    v_lshlrev_b32 v24, 16, v51
    v_and_b32 v25, s44, v51
    v_lshlrev_b32 v26, 16, v52
    v_and_b32 v27, s44, v52
    v_lshlrev_b32 v28, 16, v53
    v_and_b32 v29, s44, v53
    v_lshlrev_b32 v30, 16, v54
    v_and_b32 v31, s44, v54
    v_lshlrev_b32 v32, 16, v55
    v_and_b32 v33, s44, v55
    v_pk_add_f32 v[2:3], v[2:3], v[18:19]
    v_pk_add_f32 v[4:5], v[4:5], v[20:21]
    v_pk_add_f32 v[6:7], v[6:7], v[22:23]
    v_pk_add_f32 v[8:9], v[8:9], v[24:25]
    v_pk_add_f32 v[2:3], v[2:3], v[26:27]
    v_pk_add_f32 v[4:5], v[4:5], v[28:29]
    v_pk_add_f32 v[6:7], v[6:7], v[30:31]
    v_pk_add_f32 v[8:9], v[8:9], v[32:33]
    v_max3_f32 v10, v10, v18, v26
    v_max3_f32 v11, v11, v19, v27
    v_max3_f32 v12, v12, v20, v28
    v_max3_f32 v13, v13, v21, v29
    v_max3_f32 v14, v14, v22, v30
    v_max3_f32 v15, v15, v23, v31
    v_max3_f32 v16, v16, v24, v32
    v_max3_f32 v17, v17, v25, v33
    s_waitcnt vmcnt(2)
    buffer_load_dwordx4 v[72:75], v38, s[8:11], s84 offen nt
    s_add_u32 s85, s84, 6291456
    buffer_load_dwordx4 v[76:79], v39, s[8:11], s84 offen nt
    v_lshlrev_b32 v18, 16, v56
    v_and_b32 v19, s44, v56
    v_lshlrev_b32 v20, 16, v57
    v_and_b32 v21, s44, v57
    v_lshlrev_b32 v22, 16, v58
    v_and_b32 v23, s44, v58
    v_lshlrev_b32 v24, 16, v59
    v_and_b32 v25, s44, v59
    v_lshlrev_b32 v26, 16, v60
    v_and_b32 v27, s44, v60
    v_lshlrev_b32 v28, 16, v61
    v_and_b32 v29, s44, v61
    v_lshlrev_b32 v30, 16, v62
    v_and_b32 v31, s44, v62
    v_lshlrev_b32 v32, 16, v63
    v_and_b32 v33, s44, v63
    v_pk_add_f32 v[2:3], v[2:3], v[18:19]
    v_pk_add_f32 v[4:5], v[4:5], v[20:21]
    v_pk_add_f32 v[6:7], v[6:7], v[22:23]
    v_pk_add_f32 v[8:9], v[8:9], v[24:25]
    v_pk_add_f32 v[2:3], v[2:3], v[26:27]
    v_pk_add_f32 v[4:5], v[4:5], v[28:29]
    v_pk_add_f32 v[6:7], v[6:7], v[30:31]
    v_pk_add_f32 v[8:9], v[8:9], v[32:33]
    v_max3_f32 v10, v10, v18, v26
    v_max3_f32 v11, v11, v19, v27
    v_max3_f32 v12, v12, v20, v28
    v_max3_f32 v13, v13, v21, v29
    v_max3_f32 v14, v14, v22, v30
    v_max3_f32 v15, v15, v23, v31
    v_max3_f32 v16, v16, v24, v32
    v_max3_f32 v17, v17, v25, v33
    s_waitcnt vmcnt(2)
    s_load_dword s56, s[28:29], 0
    s_load_dword s57, s[28:29], 128
    s_load_dwordx2 s[58:59], s[28:29], 192
    s_sub_u32 s42, s12, s8
    s_add_u32 s42, s42, 0x800
    s_bitcmp1_b32 s42, 12
    s_mov_b32 s42, 0xaaaa
    s_cmov_b32 s42, 0xfefe
    v_add_u32 v19, s51, v35
    v_and_b32 v19, 15, v19
    v_bfe_u32 v19, s42, v19, 1
    v_cmp_ne_u32 vcc, 0, v19
    s_and_b32 s42, s8, 0x1fffff
    s_and_b32 s43, s12, 0x1fffff
    v_mov_b32 v20, s42
    v_mov_b32 v21, s43
    v_cndmask_b32 v20, v20, v21, vcc
    v_and_b32 v18, 15, v35
    v_add_u32 v21, s80, v20
    v_lshrrev_b32 v21, 21, v21
    v_mad_u32_u24 v18, v18, 3, v21
    v_lshrrev_b32 v21, 2, v18
    v_min_u32 v21, 11, v21
    v_mad_u32_u24 v19, v19, 12, v21
    s_waitcnt lgkmcnt(0)
    s_lshl_b32 s42, s58, 12
    s_or_b32 s42, s42, s57
    s_and_b32 s42, s42, s56
    s_andn2_b32 s42, 0x1fff, s42
    s_cbranch_scc0 L_mapok
    v_mov_b32 v26, 0
L_map:
    buffer_load_dword v22, v26, s[16:19], 0 offen sc1
    buffer_load_dword v23, v26, s[16:19], 0 offen offset:128 sc1
    buffer_load_dwordx2 v[24:25], v26, s[16:19], 0 offen offset:192 sc1
    s_add_u32 s45, s45, 1
    s_waitcnt vmcnt(0)
    v_readfirstlane_b32 s56, v22
    v_readfirstlane_b32 s57, v23
    v_readfirstlane_b32 s58, v24
    v_readfirstlane_b32 s59, v25
    s_lshl_b32 s42, s58, 12
    s_or_b32 s42, s42, s57
    s_and_b32 s42, s42, s56
    s_andn2_b32 s42, 0x1fff, s42
    s_cbranch_scc0 L_mapok
    s_cmp_lt_u32 s45, 4194304
    s_cbranch_scc1 L_map
L_mapok:
    s_and_b32 s46, s59, 0xffff
    s_lshr_b32 s52, s59, 16
    s_and_b32 s42, s56, 0x10000000
    s_or_b32 s57, s57, s42
    s_lshr_b32 s57, s57, 16
    s_lshl_b32 s57, s57, 12
    s_bfe_u32 s42, s56, 0xc0010
    s_or_b32 s57, s57, s42
    s_lshr_b32 s56, s56, 29
    s_lshl_b32 s42, s57, 1
    s_lshr_b32 s43, s57, 2
    s_and_b32 s42, s42, 0xffeffe
    s_and_b32 s43, s43, 0x1001
    s_or_b32 s42, s42, s43
    s_lshr_b32 s43, s57, 1
    s_lshl_b32 s48, s57, 2
    s_and_b32 s43, s43, 0x7ff7ff
    s_and_b32 s48, s48, 0x800800
    s_or_b32 s43, s43, s48
    s_and_b32 s48, s42, s43
    s_or_b32 s42, s42, s43
    s_bitset1_b32 s42, 24
    s_and_b32 s57, s57, s42
    s_or_b32 s57, s57, s48
    s_add_u32 s42, s56, s2
    s_lshr_b32 s42, s42, 2
    v_lshrrev_b32 v19, v19, s57
    v_xor_b32 v18, s42, v18
    v_xor_b32 v19, v18, v19
    s_mov_b32 exec_lo, 0xffffffe0
    v_lshl_add_u32 v34, v19, 13, v20
    s_mov_b32 exec_lo, -1
    v_readlane_b32 s50, v34, 5
    s_add_u32 s86, s85, 6291456
    s_nop 0
    v_add_u32 v39, s50, v0
    v_bfe_u32 v39, v39, 13, 1
    v_mad_u32_u24 v39, v39, s49, v0
    buffer_load_dwordx4 v[80:83], v39, s[8:11], s85 offen nt
    v_add_u32 v39, s50, v1
    v_bfe_u32 v39, v39, 13, 1
    v_mad_u32_u24 v39, v39, s49, v1
    buffer_load_dwordx4 v[84:87], v39, s[8:11], s85 offen nt
    v_lshlrev_b32 v18, 16, v64
    v_and_b32 v19, s44, v64
    v_lshlrev_b32 v20, 16, v65
    v_and_b32 v21, s44, v65
    v_lshlrev_b32 v22, 16, v66
    v_and_b32 v23, s44, v66
    v_lshlrev_b32 v24, 16, v67
    v_and_b32 v25, s44, v67
    v_lshlrev_b32 v26, 16, v68
    v_and_b32 v27, s44, v68
    v_lshlrev_b32 v28, 16, v69
    v_and_b32 v29, s44, v69
    v_lshlrev_b32 v30, 16, v70
    v_and_b32 v31, s44, v70
    v_lshlrev_b32 v32, 16, v71
    v_and_b32 v33, s44, v71
    v_pk_add_f32 v[2:3], v[2:3], v[18:19]
    v_pk_add_f32 v[4:5], v[4:5], v[20:21]
    v_pk_add_f32 v[6:7], v[6:7], v[22:23]
    v_pk_add_f32 v[8:9], v[8:9], v[24:25]
    v_pk_add_f32 v[2:3], v[2:3], v[26:27]
    v_pk_add_f32 v[4:5], v[4:5], v[28:29]
    v_pk_add_f32 v[6:7], v[6:7], v[30:31]
    v_pk_add_f32 v[8:9], v[8:9], v[32:33]
    v_max3_f32 v10, v10, v18, v26
    v_max3_f32 v11, v11, v19, v27
    v_max3_f32 v12, v12, v20, v28
    v_max3_f32 v13, v13, v21, v29
    v_max3_f32 v14, v14, v22, v30
    v_max3_f32 v15, v15, v23, v31
    v_max3_f32 v16, v16, v24, v32
    v_max3_f32 v17, v17, v25, v33
    s_waitcnt vmcnt(2)
    v_readlane_b32 s50, v34, 6
    s_add_u32 s87, s86, 6291456
    s_nop 0
    v_add_u32 v39, s50, v0
    v_bfe_u32 v39, v39, 13, 1
    v_mad_u32_u24 v39, v39, s49, v0
    buffer_load_dwordx4 v[88:91], v39, s[8:11], s86 offen nt
    v_add_u32 v39, s50, v1
    v_bfe_u32 v39, v39, 13, 1
    v_mad_u32_u24 v39, v39, s49, v1
    buffer_load_dwordx4 v[92:95], v39, s[8:11], s86 offen nt
    v_lshlrev_b32 v18, 16, v72
    v_and_b32 v19, s44, v72
    v_lshlrev_b32 v20, 16, v73
    v_and_b32 v21, s44, v73
    v_lshlrev_b32 v22, 16, v74
    v_and_b32 v23, s44, v74
    v_lshlrev_b32 v24, 16, v75
    v_and_b32 v25, s44, v75
    v_lshlrev_b32 v26, 16, v76
    v_and_b32 v27, s44, v76
    v_lshlrev_b32 v28, 16, v77
    v_and_b32 v29, s44, v77
    v_lshlrev_b32 v30, 16, v78
    v_and_b32 v31, s44, v78
    v_lshlrev_b32 v32, 16, v79
    v_and_b32 v33, s44, v79
    v_pk_add_f32 v[2:3], v[2:3], v[18:19]
    v_pk_add_f32 v[4:5], v[4:5], v[20:21]
    v_pk_add_f32 v[6:7], v[6:7], v[22:23]
    v_pk_add_f32 v[8:9], v[8:9], v[24:25]
    v_pk_add_f32 v[2:3], v[2:3], v[26:27]
    v_pk_add_f32 v[4:5], v[4:5], v[28:29]
    v_pk_add_f32 v[6:7], v[6:7], v[30:31]
    v_pk_add_f32 v[8:9], v[8:9], v[32:33]
    v_max3_f32 v10, v10, v18, v26
    v_max3_f32 v11, v11, v19, v27
    v_max3_f32 v12, v12, v20, v28
    v_max3_f32 v13, v13, v21, v29
    v_max3_f32 v14, v14, v22, v30
    v_max3_f32 v15, v15, v23, v31
    v_max3_f32 v16, v16, v24, v32
    v_max3_f32 v17, v17, v25, v33
    s_waitcnt vmcnt(2)
    v_readlane_b32 s50, v34, 7
    s_add_u32 s88, s87, 6291456
    s_nop 0
    v_add_u32 v39, s50, v0
    v_bfe_u32 v39, v39, 13, 1
    v_mad_u32_u24 v39, v39, s49, v0
    buffer_load_dwordx4 v[96:99], v39, s[8:11], s87 offen nt
    v_add_u32 v39, s50, v1
    v_bfe_u32 v39, v39, 13, 1
    v_mad_u32_u24 v39, v39, s49, v1
    buffer_load_dwordx4 v[100:103], v39, s[8:11], s87 offen nt
    v_lshlrev_b32 v18, 16, v80
    v_and_b32 v19, s44, v80
    v_lshlrev_b32 v20, 16, v81
    v_and_b32 v21, s44, v81
    v_lshlrev_b32 v22, 16, v82
    v_and_b32 v23, s44, v82
    v_lshlrev_b32 v24, 16, v83
    v_and_b32 v25, s44, v83
    v_lshlrev_b32 v26, 16, v84
    v_and_b32 v27, s44, v84
    v_lshlrev_b32 v28, 16, v85
    v_and_b32 v29, s44, v85
    v_lshlrev_b32 v30, 16, v86
    v_and_b32 v31, s44, v86
    v_lshlrev_b32 v32, 16, v87
    v_and_b32 v33, s44, v87
    v_pk_add_f32 v[2:3], v[2:3], v[18:19]
    v_pk_add_f32 v[4:5], v[4:5], v[20:21]
    v_pk_add_f32 v[6:7], v[6:7], v[22:23]
    v_pk_add_f32 v[8:9], v[8:9], v[24:25]
    v_pk_add_f32 v[2:3], v[2:3], v[26:27]
    v_pk_add_f32 v[4:5], v[4:5], v[28:29]
    v_pk_add_f32 v[6:7], v[6:7], v[30:31]
    v_pk_add_f32 v[8:9], v[8:9], v[32:33]
    v_max3_f32 v10, v10, v18, v26
    v_max3_f32 v11, v11, v19, v27
    v_max3_f32 v12, v12, v20, v28
    v_max3_f32 v13, v13, v21, v29
    v_max3_f32 v14, v14, v22, v30
    v_max3_f32 v15, v15, v23, v31
    v_max3_f32 v16, v16, v24, v32
    v_max3_f32 v17, v17, v25, v33
    s_waitcnt vmcnt(2)
    v_readlane_b32 s50, v34, 8
    s_add_u32 s89, s88, 6291456
    s_nop 0
    v_add_u32 v39, s50, v0
    v_bfe_u32 v39, v39, 13, 1
    v_mad_u32_u24 v39, v39, s49, v0
    buffer_load_dwordx4 v[104:107], v39, s[8:11], s88 offen nt
    s_cmp_ge_u32 s36, 6
    s_cselect_b32 s32, s24, s6
    s_cselect_b32 s33, s25, s7
    s_cselect_b32 s42, 18432, 0
    s_mov_b32 s34, 18432
    s_mul_i32 s43, s36, 3072
    s_mov_b32 m0, s43
    s_sub_u32 s42, s43, s42
    buffer_load_dwordx4 v36, s[32:35], s42 offen offset:0 lds
    buffer_load_dwordx4 v36, s[32:35], s42 offen offset:1024 lds
    buffer_load_dwordx4 v36, s[32:35], s42 offen offset:2048 lds
    v_add_u32 v39, s50, v1
    v_bfe_u32 v39, v39, 13, 1
    v_mad_u32_u24 v39, v39, s49, v1
    buffer_load_dwordx4 v[108:111], v39, s[8:11], s88 offen nt
    v_lshlrev_b32 v18, 16, v88
    v_and_b32 v19, s44, v88
    v_lshlrev_b32 v20, 16, v89
    v_and_b32 v21, s44, v89
    v_lshlrev_b32 v22, 16, v90
    v_and_b32 v23, s44, v90
    v_lshlrev_b32 v24, 16, v91
    v_and_b32 v25, s44, v91
    v_lshlrev_b32 v26, 16, v92
    v_and_b32 v27, s44, v92
    v_lshlrev_b32 v28, 16, v93
    v_and_b32 v29, s44, v93
    v_lshlrev_b32 v30, 16, v94
    v_and_b32 v31, s44, v94
    v_lshlrev_b32 v32, 16, v95
    v_and_b32 v33, s44, v95
    v_pk_add_f32 v[2:3], v[2:3], v[18:19]
    v_pk_add_f32 v[4:5], v[4:5], v[20:21]
    v_pk_add_f32 v[6:7], v[6:7], v[22:23]
    v_pk_add_f32 v[8:9], v[8:9], v[24:25]
    v_pk_add_f32 v[2:3], v[2:3], v[26:27]
    v_pk_add_f32 v[4:5], v[4:5], v[28:29]
    v_pk_add_f32 v[6:7], v[6:7], v[30:31]
    v_pk_add_f32 v[8:9], v[8:9], v[32:33]
    v_max3_f32 v10, v10, v18, v26
    v_max3_f32 v11, v11, v19, v27
    v_max3_f32 v12, v12, v20, v28
    v_max3_f32 v13, v13, v21, v29
    v_max3_f32 v14, v14, v22, v30
    v_max3_f32 v15, v15, v23, v31
    v_max3_f32 v16, v16, v24, v32
    v_max3_f32 v17, v17, v25, v33
    s_waitcnt vmcnt(5)
    v_readlane_b32 s50, v34, 9
    s_add_u32 s90, s89, 6291456
    s_nop 0
    v_add_u32 v39, s50, v0
    v_bfe_u32 v39, v39, 13, 1
    v_mad_u32_u24 v39, v39, s49, v0
    buffer_load_dwordx4 v[112:115], v39, s[8:11], s89 offen nt
    v_add_u32 v39, s50, v1
    v_bfe_u32 v39, v39, 13, 1
    v_mad_u32_u24 v39, v39, s49, v1
    buffer_load_dwordx4 v[116:119], v39, s[8:11], s89 offen nt
    v_lshlrev_b32 v18, 16, v96
    v_and_b32 v19, s44, v96
    v_lshlrev_b32 v20, 16, v97
    v_and_b32 v21, s44, v97
    v_lshlrev_b32 v22, 16, v98
    v_and_b32 v23, s44, v98
    v_lshlrev_b32 v24, 16, v99
    v_and_b32 v25, s44, v99
    v_lshlrev_b32 v26, 16, v100
    v_and_b32 v27, s44, v100
    v_lshlrev_b32 v28, 16, v101
    v_and_b32 v29, s44, v101
    v_lshlrev_b32 v30, 16, v102
    v_and_b32 v31, s44, v102
    v_lshlrev_b32 v32, 16, v103
    v_and_b32 v33, s44, v103
    v_pk_add_f32 v[2:3], v[2:3], v[18:19]
    v_pk_add_f32 v[4:5], v[4:5], v[20:21]
    v_pk_add_f32 v[6:7], v[6:7], v[22:23]
    v_pk_add_f32 v[8:9], v[8:9], v[24:25]
    v_pk_add_f32 v[2:3], v[2:3], v[26:27]
    v_pk_add_f32 v[4:5], v[4:5], v[28:29]
    v_pk_add_f32 v[6:7], v[6:7], v[30:31]
    v_pk_add_f32 v[8:9], v[8:9], v[32:33]
    v_max3_f32 v10, v10, v18, v26
    v_max3_f32 v11, v11, v19, v27
    v_max3_f32 v12, v12, v20, v28
    v_max3_f32 v13, v13, v21, v29
    v_max3_f32 v14, v14, v22, v30
    v_max3_f32 v15, v15, v23, v31
    v_max3_f32 v16, v16, v24, v32
    v_max3_f32 v17, v17, v25, v33
    s_waitcnt vmcnt(2)
    v_readlane_b32 s50, v34, 10
    s_add_u32 s91, s90, 6291456
    s_nop 0
    v_add_u32 v39, s50, v0
    v_bfe_u32 v39, v39, 13, 1
    v_mad_u32_u24 v39, v39, s49, v0
    buffer_load_dwordx4 v[120:123], v39, s[8:11], s90 offen nt
    v_add_u32 v39, s50, v1
    v_bfe_u32 v39, v39, 13, 1
    v_mad_u32_u24 v39, v39, s49, v1
    buffer_load_dwordx4 v[124:127], v39, s[8:11], s90 offen nt
    v_lshlrev_b32 v18, 16, v104
    v_and_b32 v19, s44, v104
    v_lshlrev_b32 v20, 16, v105
    v_and_b32 v21, s44, v105
    v_lshlrev_b32 v22, 16, v106
    v_and_b32 v23, s44, v106
    v_lshlrev_b32 v24, 16, v107
    v_and_b32 v25, s44, v107
    v_lshlrev_b32 v26, 16, v108
    v_and_b32 v27, s44, v108
    v_lshlrev_b32 v28, 16, v109
    v_and_b32 v29, s44, v109
    v_lshlrev_b32 v30, 16, v110
    v_and_b32 v31, s44, v110
    v_lshlrev_b32 v32, 16, v111
    v_and_b32 v33, s44, v111
    v_pk_add_f32 v[2:3], v[2:3], v[18:19]
    v_pk_add_f32 v[4:5], v[4:5], v[20:21]
    v_pk_add_f32 v[6:7], v[6:7], v[22:23]
    v_pk_add_f32 v[8:9], v[8:9], v[24:25]
    v_pk_add_f32 v[2:3], v[2:3], v[26:27]
    v_pk_add_f32 v[4:5], v[4:5], v[28:29]
    v_pk_add_f32 v[6:7], v[6:7], v[30:31]
    v_pk_add_f32 v[8:9], v[8:9], v[32:33]
    v_max3_f32 v10, v10, v18, v26
    v_max3_f32 v11, v11, v19, v27
    v_max3_f32 v12, v12, v20, v28
    v_max3_f32 v13, v13, v21, v29
    v_max3_f32 v14, v14, v22, v30
    v_max3_f32 v15, v15, v23, v31
    v_max3_f32 v16, v16, v24, v32
    v_max3_f32 v17, v17, v25, v33
    v_and_b32 v37, 6, v35
    v_lshrrev_b32 v38, 3, v35
    v_lshl_add_u32 v37, v37, 2, v38
    v_and_b32 v38, 1, v35
    v_lshl_add_u32 v37, v37, 1, v38
    s_mul_i32 s42, s37, 1536
    s_lshl_b32 s43, s38, 9
    s_add_u32 s42, s42, s43
    v_lshl_add_u32 v37, v37, 3, s42
    s_mul_i32 s43, s36, 768
    v_add_u32 v38, s43, v36
    s_mul_i32 s48, s2, 1536
    s_add_u32 s48, s48, s43
    s_add_u32 s48, s48, 262144
    s_waitcnt vmcnt(2)
    v_readlane_b32 s50, v34, 11
    s_add_u32 s92, s91, 6291456
    s_nop 0
    v_add_u32 v39, s50, v0
    v_bfe_u32 v39, v39, 13, 1
    v_mad_u32_u24 v39, v39, s49, v0
    buffer_load_dwordx4 v[128:131], v39, s[8:11], s91 offen nt
    v_add_u32 v39, s50, v1
    v_bfe_u32 v39, v39, 13, 1
    v_mad_u32_u24 v39, v39, s49, v1
    buffer_load_dwordx4 v[132:135], v39, s[8:11], s91 offen nt
    s_barrier
    v_lshlrev_b32 v18, 16, v112
    v_and_b32 v19, s44, v112
    v_lshlrev_b32 v20, 16, v113
    v_and_b32 v21, s44, v113
    v_lshlrev_b32 v22, 16, v114
    v_and_b32 v23, s44, v114
    v_lshlrev_b32 v24, 16, v115
    v_and_b32 v25, s44, v115
    v_lshlrev_b32 v26, 16, v116
    v_and_b32 v27, s44, v116
    v_lshlrev_b32 v28, 16, v117
    v_and_b32 v29, s44, v117
    v_lshlrev_b32 v30, 16, v118
    v_and_b32 v31, s44, v118
    v_lshlrev_b32 v32, 16, v119
    v_and_b32 v33, s44, v119
    v_pk_add_f32 v[2:3], v[2:3], v[18:19]
    v_pk_add_f32 v[4:5], v[4:5], v[20:21]
    v_pk_add_f32 v[6:7], v[6:7], v[22:23]
    v_pk_add_f32 v[8:9], v[8:9], v[24:25]
    v_pk_add_f32 v[2:3], v[2:3], v[26:27]
    v_pk_add_f32 v[4:5], v[4:5], v[28:29]
    v_pk_add_f32 v[6:7], v[6:7], v[30:31]
    v_pk_add_f32 v[8:9], v[8:9], v[32:33]
    v_max3_f32 v10, v10, v18, v26
    v_max3_f32 v11, v11, v19, v27
    v_max3_f32 v12, v12, v20, v28
    v_max3_f32 v13, v13, v21, v29
    v_max3_f32 v14, v14, v22, v30
    v_max3_f32 v15, v15, v23, v31
    v_max3_f32 v16, v16, v24, v32
    v_max3_f32 v17, v17, v25, v33
    s_waitcnt vmcnt(2)
    v_readlane_b32 s50, v34, 12
    s_add_u32 s93, s92, 6291456
    s_nop 0
    v_add_u32 v39, s50, v0
    v_bfe_u32 v39, v39, 13, 1
    v_mad_u32_u24 v39, v39, s49, v0
    buffer_load_dwordx4 v[136:139], v39, s[8:11], s92 offen nt
    v_add_u32 v39, s50, v1
    v_bfe_u32 v39, v39, 13, 1
    v_mad_u32_u24 v39, v39, s49, v1
    buffer_load_dwordx4 v[140:143], v39, s[8:11], s92 offen nt
    v_lshlrev_b32 v18, 16, v120
    v_and_b32 v19, s44, v120
    v_lshlrev_b32 v20, 16, v121
    v_and_b32 v21, s44, v121
    v_lshlrev_b32 v22, 16, v122
    v_and_b32 v23, s44, v122
    v_lshlrev_b32 v24, 16, v123
    v_and_b32 v25, s44, v123
    v_lshlrev_b32 v26, 16, v124
    v_and_b32 v27, s44, v124
    v_lshlrev_b32 v28, 16, v125
    v_and_b32 v29, s44, v125
    v_lshlrev_b32 v30, 16, v126
    v_and_b32 v31, s44, v126
    v_lshlrev_b32 v32, 16, v127
    v_and_b32 v33, s44, v127
    v_pk_add_f32 v[2:3], v[2:3], v[18:19]
    v_pk_add_f32 v[4:5], v[4:5], v[20:21]
    v_pk_add_f32 v[6:7], v[6:7], v[22:23]
    v_pk_add_f32 v[8:9], v[8:9], v[24:25]
    v_pk_add_f32 v[2:3], v[2:3], v[26:27]
    v_pk_add_f32 v[4:5], v[4:5], v[28:29]
    v_pk_add_f32 v[6:7], v[6:7], v[30:31]
    v_pk_add_f32 v[8:9], v[8:9], v[32:33]
    v_max3_f32 v10, v10, v18, v26
    v_max3_f32 v11, v11, v19, v27
    v_max3_f32 v12, v12, v20, v28
    v_max3_f32 v13, v13, v21, v29
    v_max3_f32 v14, v14, v22, v30
    v_max3_f32 v15, v15, v23, v31
    v_max3_f32 v16, v16, v24, v32
    v_max3_f32 v17, v17, v25, v33
    s_waitcnt vmcnt(2)
    v_readlane_b32 s50, v34, 13
    s_add_u32 s94, s93, 6291456
    s_nop 0
    v_add_u32 v39, s50, v0
    v_bfe_u32 v39, v39, 13, 1
    v_mad_u32_u24 v39, v39, s49, v0
    buffer_load_dwordx4 v[144:147], v39, s[8:11], s93 offen nt
    v_add_u32 v39, s50, v1
    v_bfe_u32 v39, v39, 13, 1
    v_mad_u32_u24 v39, v39, s49, v1
    buffer_load_dwordx4 v[148:151], v39, s[8:11], s93 offen nt
    v_readlane_b32 s50, v34, 14
    s_add_u32 s95, s94, 6291456
    s_nop 0
    v_add_u32 v39, s50, v0
    v_bfe_u32 v39, v39, 13, 1
    v_mad_u32_u24 v39, v39, s49, v0
    buffer_load_dwordx4 v[152:155], v39, s[8:11], s94 offen nt
    v_add_u32 v39, s50, v1
    v_bfe_u32 v39, v39, 13, 1
    v_mad_u32_u24 v39, v39, s49, v1
    buffer_load_dwordx4 v[156:159], v39, s[8:11], s94 offen nt
    v_lshlrev_b32 v18, 16, v128
    v_and_b32 v19, s44, v128
    v_lshlrev_b32 v20, 16, v129
    v_and_b32 v21, s44, v129
    v_lshlrev_b32 v22, 16, v130
    v_and_b32 v23, s44, v130
    v_lshlrev_b32 v24, 16, v131
    v_and_b32 v25, s44, v131
    v_lshlrev_b32 v26, 16, v132
    v_and_b32 v27, s44, v132
    v_lshlrev_b32 v28, 16, v133
    v_and_b32 v29, s44, v133
    v_lshlrev_b32 v30, 16, v134
    v_and_b32 v31, s44, v134
    v_lshlrev_b32 v32, 16, v135
    v_and_b32 v33, s44, v135
    v_pk_add_f32 v[2:3], v[2:3], v[18:19]
    v_pk_add_f32 v[4:5], v[4:5], v[20:21]
    v_pk_add_f32 v[6:7], v[6:7], v[22:23]
    v_pk_add_f32 v[8:9], v[8:9], v[24:25]
    v_pk_add_f32 v[2:3], v[2:3], v[26:27]
    v_pk_add_f32 v[4:5], v[4:5], v[28:29]
    v_pk_add_f32 v[6:7], v[6:7], v[30:31]
    v_pk_add_f32 v[8:9], v[8:9], v[32:33]
    v_max3_f32 v10, v10, v18, v26
    v_max3_f32 v11, v11, v19, v27
    v_max3_f32 v12, v12, v20, v28
    v_max3_f32 v13, v13, v21, v29
    v_max3_f32 v14, v14, v22, v30
    v_max3_f32 v15, v15, v23, v31
    v_max3_f32 v16, v16, v24, v32
    v_max3_f32 v17, v17, v25, v33
    s_waitcnt vmcnt(4)
    v_readlane_b32 s50, v34, 15
    s_nop 1
    v_add_u32 v39, s50, v0
    v_bfe_u32 v39, v39, 13, 1
    v_mad_u32_u24 v39, v39, s49, v0
    buffer_load_dwordx4 v[160:163], v39, s[8:11], s95 offen nt
    v_add_u32 v39, s50, v1
    v_bfe_u32 v39, v39, 13, 1
    v_mad_u32_u24 v39, v39, s49, v1
    buffer_load_dwordx4 v[164:167], v39, s[8:11], s95 offen nt
    s_cmp_lg_u32 s36, 0
    s_cbranch_scc1 L_notouch
    v_lshlrev_b32 v39, 7, v35
    s_mov_b64 exec, 0xfff
    buffer_load_dword v39, v39, s[20:23], s48 offen sc1
    s_mov_b64 exec, -1
L_notouch:
    v_lshlrev_b32 v18, 16, v136
    v_and_b32 v19, s44, v136
    v_lshlrev_b32 v20, 16, v137
    v_and_b32 v21, s44, v137
    v_lshlrev_b32 v22, 16, v138
    v_and_b32 v23, s44, v138
    v_lshlrev_b32 v24, 16, v139
    v_and_b32 v25, s44, v139
    v_lshlrev_b32 v26, 16, v140
    v_and_b32 v27, s44, v140
    v_lshlrev_b32 v28, 16, v141
    v_and_b32 v29, s44, v141
    v_lshlrev_b32 v30, 16, v142
    v_and_b32 v31, s44, v142
    v_lshlrev_b32 v32, 16, v143
    v_and_b32 v33, s44, v143
    v_pk_add_f32 v[2:3], v[2:3], v[18:19]
    v_pk_add_f32 v[4:5], v[4:5], v[20:21]
    v_pk_add_f32 v[6:7], v[6:7], v[22:23]
    v_pk_add_f32 v[8:9], v[8:9], v[24:25]
    v_pk_add_f32 v[2:3], v[2:3], v[26:27]
    v_pk_add_f32 v[4:5], v[4:5], v[28:29]
    v_pk_add_f32 v[6:7], v[6:7], v[30:31]
    v_pk_add_f32 v[8:9], v[8:9], v[32:33]
    v_max3_f32 v10, v10, v18, v26
    v_max3_f32 v11, v11, v19, v27
    v_max3_f32 v12, v12, v20, v28
    v_max3_f32 v13, v13, v21, v29
    v_max3_f32 v14, v14, v22, v30
    v_max3_f32 v15, v15, v23, v31
    v_max3_f32 v16, v16, v24, v32
    v_max3_f32 v17, v17, v25, v33
    s_waitcnt vmcnt(4)
    v_lshlrev_b32 v18, 16, v144
    v_and_b32 v19, s44, v144
    v_lshlrev_b32 v20, 16, v145
    v_and_b32 v21, s44, v145
    v_lshlrev_b32 v22, 16, v146
    v_and_b32 v23, s44, v146
    v_lshlrev_b32 v24, 16, v147
    v_and_b32 v25, s44, v147
    v_lshlrev_b32 v26, 16, v148
    v_and_b32 v27, s44, v148
    v_lshlrev_b32 v28, 16, v149
    v_and_b32 v29, s44, v149
    v_lshlrev_b32 v30, 16, v150
    v_and_b32 v31, s44, v150
    v_lshlrev_b32 v32, 16, v151
    v_and_b32 v33, s44, v151
    v_pk_add_f32 v[2:3], v[2:3], v[18:19]
    v_pk_add_f32 v[4:5], v[4:5], v[20:21]
    v_pk_add_f32 v[6:7], v[6:7], v[22:23]
    v_pk_add_f32 v[8:9], v[8:9], v[24:25]
    v_pk_add_f32 v[2:3], v[2:3], v[26:27]
    v_pk_add_f32 v[4:5], v[4:5], v[28:29]
    v_pk_add_f32 v[6:7], v[6:7], v[30:31]
    v_pk_add_f32 v[8:9], v[8:9], v[32:33]
    v_max3_f32 v10, v10, v18, v26
    v_max3_f32 v11, v11, v19, v27
    v_max3_f32 v12, v12, v20, v28
    v_max3_f32 v13, v13, v21, v29
    v_max3_f32 v14, v14, v22, v30
    v_max3_f32 v15, v15, v23, v31
    v_max3_f32 v16, v16, v24, v32
    v_max3_f32 v17, v17, v25, v33
    s_waitcnt vmcnt(2)
    v_lshlrev_b32 v18, 16, v152
    v_and_b32 v19, s44, v152
    v_lshlrev_b32 v20, 16, v153
    v_and_b32 v21, s44, v153
    v_lshlrev_b32 v22, 16, v154
    v_and_b32 v23, s44, v154
    v_lshlrev_b32 v24, 16, v155
    v_and_b32 v25, s44, v155
    v_lshlrev_b32 v26, 16, v156
    v_and_b32 v27, s44, v156
    v_lshlrev_b32 v28, 16, v157
    v_and_b32 v29, s44, v157
    v_lshlrev_b32 v30, 16, v158
    v_and_b32 v31, s44, v158
    v_lshlrev_b32 v32, 16, v159
    v_and_b32 v33, s44, v159
    v_pk_add_f32 v[2:3], v[2:3], v[18:19]
    v_pk_add_f32 v[4:5], v[4:5], v[20:21]
    v_pk_add_f32 v[6:7], v[6:7], v[22:23]
    v_pk_add_f32 v[8:9], v[8:9], v[24:25]
    v_pk_add_f32 v[2:3], v[2:3], v[26:27]
    v_pk_add_f32 v[4:5], v[4:5], v[28:29]
    v_pk_add_f32 v[6:7], v[6:7], v[30:31]
    v_pk_add_f32 v[8:9], v[8:9], v[32:33]
    v_max3_f32 v10, v10, v18, v26
    v_max3_f32 v11, v11, v19, v27
    v_max3_f32 v12, v12, v20, v28
    v_max3_f32 v13, v13, v21, v29
    v_max3_f32 v14, v14, v22, v30
    v_max3_f32 v15, v15, v23, v31
    v_max3_f32 v16, v16, v24, v32
    v_max3_f32 v17, v17, v25, v33
    s_branch L_pageT
.p2align 12
L_pageT:
    s_waitcnt vmcnt(1)
    v_lshlrev_b32 v18, 16, v160
    v_and_b32 v19, s44, v160
    v_lshlrev_b32 v20, 16, v161
    v_and_b32 v21, s44, v161
    v_lshlrev_b32 v22, 16, v162
    v_and_b32 v23, s44, v162
    v_lshlrev_b32 v24, 16, v163
    v_and_b32 v25, s44, v163
    v_pk_add_f32 v[2:3], v[2:3], v[18:19]
    v_pk_add_f32 v[4:5], v[4:5], v[20:21]
    v_pk_add_f32 v[6:7], v[6:7], v[22:23]
    v_pk_add_f32 v[8:9], v[8:9], v[24:25]
    v_max_f32 v10, v10, v18
    v_max_f32 v11, v11, v19
    v_max_f32 v12, v12, v20
    v_max_f32 v13, v13, v21
    v_max_f32 v14, v14, v22
    v_max_f32 v15, v15, v23
    v_max_f32 v16, v16, v24
    v_max_f32 v17, v17, v25
    s_waitcnt vmcnt(0)
    v_lshlrev_b32 v18, 16, v164
    v_and_b32 v19, s44, v164
    v_lshlrev_b32 v20, 16, v165
    v_and_b32 v21, s44, v165
    v_lshlrev_b32 v22, 16, v166
    v_and_b32 v23, s44, v166
    v_lshlrev_b32 v24, 16, v167
    v_and_b32 v25, s44, v167
    v_pk_add_f32 v[2:3], v[2:3], v[18:19]
    v_pk_add_f32 v[4:5], v[4:5], v[20:21]
    v_pk_add_f32 v[6:7], v[6:7], v[22:23]
    v_pk_add_f32 v[8:9], v[8:9], v[24:25]
    v_max_f32 v10, v10, v18
    v_max_f32 v11, v11, v19
    v_max_f32 v12, v12, v20
    v_max_f32 v13, v13, v21
    v_max_f32 v14, v14, v22
    v_max_f32 v15, v15, v23
    v_max_f32 v16, v16, v24
    v_max_f32 v17, v17, v25
    v_permlane32_swap_b32 v2, v6
    v_permlane32_swap_b32 v3, v7
    v_permlane32_swap_b32 v4, v8
    v_permlane32_swap_b32 v5, v9
    v_permlane32_swap_b32 v10, v14
    v_permlane32_swap_b32 v11, v15
    v_permlane32_swap_b32 v12, v16
    v_permlane32_swap_b32 v13, v17
    v_pk_add_f32 v[2:3], v[2:3], v[6:7]
    v_pk_add_f32 v[4:5], v[4:5], v[8:9]
    v_max_f32 v10, v10, v14
    v_max_f32 v11, v11, v15
    v_max_f32 v12, v12, v16
    v_max_f32 v13, v13, v17
    v_permlane16_swap_b32 v2, v4
    v_permlane16_swap_b32 v3, v5
    v_permlane16_swap_b32 v10, v12
    v_permlane16_swap_b32 v11, v13
    v_pk_add_f32 v[2:3], v[2:3], v[4:5]
    v_max_f32 v10, v10, v12
    v_max_f32 v11, v11, v13
    v_add_f32_dpp v18, v2, v2 row_ror:8 row_mask:0xf bank_mask:0x3
    v_max_f32_dpp v19, v10, v10 row_ror:8 row_mask:0xf bank_mask:0x3
    s_nop 0
    v_add_f32_dpp v18, v3, v3 row_ror:8 row_mask:0xf bank_mask:0xc
    v_max_f32_dpp v19, v11, v11 row_ror:8 row_mask:0xf bank_mask:0xc
    ds_write_b64 v37, v[18:19] offset:36864
    s_cmp_ge_u32 s36, 2
    s_waitcnt lgkmcnt(0)
    s_barrier
    s_cbranch_scc1 L_role2
    s_mov_b32 exec_hi, 0xffff
    ds_read_b128 v[18:21], v38 offset:36864
    ds_read_b128 v[22:25], v38 offset:38400
    ds_read_b128 v[26:29], v38 offset:39936
    ds_read_b128 v[30:33], v38 offset:41472
    s_waitcnt lgkmcnt(2)
    v_add_f32 v18, v18, v22
    v_add_f32 v20, v20, v24
    v_max_f32 v19, v19, v23
    v_max_f32 v21, v21, v25
    s_waitcnt lgkmcnt(0)
    v_add_f32 v26, v26, v30
    v_add_f32 v28, v28, v32
    v_max3_f32 v19, v19, v27, v31
    v_max3_f32 v21, v21, v29, v33
    v_add_f32 v18, v18, v26
    v_add_f32 v20, v20, v28
    v_or_b32 v19, s46, v19
    v_or_b32 v21, s52, v21
    buffer_store_dwordx4 v[18:21], v36, s[20:23], s48 offen
    s_barrier
    s_mov_b64 exec, -1
    s_branch L_common
L_role2:
    s_barrier
    s_lshr_b32 s47, s2, 3
    s_sub_u32 s47, s47, 16
    s_cmp_lt_u32 s47, 12
    s_cselect_b32 s42, 0x30c, 0
    s_bitcmp1_b32 s42, s36
    s_cbranch_scc0 L_role4
    v_mov_b32 v24, 0
    v_mov_b32 v25, 1
    v_lshrrev_b32 v2, 3, v35
    v_mul_u32_u24 v20, 12288, v2
    v_and_b32 v3, 0x70, v36
    v_add_u32 v20, v20, v3
    s_and_b32 s43, s2, 7
    s_mul_i32 s42, s43, 1536
    s_lshl_b32 s47, s47, 7
    s_add_u32 s42, s42, s47
    s_add_u32 s4, s42, 262144
    s_add_u32 s5, s4, 98304
    s_add_u32 s6, s5, 98304
    s_add_u32 s7, s6, 98304
    v_and_b32 v2, 3, v2
    v_add_u32 v21, s56, v2
    s_lshr_b32 s48, s57, 22
    v_xor_b32 v21, s48, v21
    v_and_b32 v21, 4, v21
    v_lshlrev_b32 v21, 11, v21
    v_lshl_add_u32 v21, v2, 15, v21
    v_lshrrev_b32 v3, 1, v3
    v_add_u32 v21, v21, v3
    v_lshrrev_b32 v3, 5, v35
    v_lshl_add_u32 v21, v3, 6, v21
    v_xor_b32 v22, 0x22000, v21
    s_bfe_u32 s43, s2, 0x10002
    s_mul_i32 s43, s43, 10240
    s_add_u32 s48, s42, s43
    v_and_b32 v23, 16, v36
    v_bfe_u32 v23, s59, v23, 16
L_pollA:
    buffer_load_dwordx4 v[4:7], v20, s[20:23], s4 offen sc1
    buffer_load_dwordx4 v[8:11], v20, s[20:23], s5 offen sc1
    buffer_load_dwordx4 v[12:15], v20, s[20:23], s6 offen sc1
    buffer_load_dwordx4 v[16:19], v20, s[20:23], s7 offen sc1
    s_add_u32 s45, s45, 1
    s_waitcnt vmcnt(3)
    v_xor_b32 v2, s46, v5
    v_bitop3_b32 v2, v2, v7, s52 bitop3:0xf6
    s_waitcnt vmcnt(2)
    v_bitop3_b32 v2, v2, v9, s46 bitop3:0xf6
    v_bitop3_b32 v2, v2, v11, s52 bitop3:0xf6
    s_waitcnt vmcnt(1)
    v_bitop3_b32 v2, v2, v13, s46 bitop3:0xf6
    v_bitop3_b32 v2, v2, v15, s52 bitop3:0xf6
    s_waitcnt vmcnt(0)
    v_bitop3_b32 v2, v2, v17, s46 bitop3:0xf6
    v_bitop3_b32 v2, v2, v19, s52 bitop3:0xf6
    v_cmp_ne_u16 vcc, 0, v2
    s_cbranch_vccz L_gotA
    s_cmp_lt_u32 s45, 4194304
    s_cbranch_scc1 L_pollA
L_gotA:
    s_mov_b64 exec, 1
    ds_wrxchg_rtn_b32 v26, v24, v25 offset:46084
    s_mov_b64 exec, -1
    v_add_f32 v4, v4, v8
    v_add_f32 v6, v6, v10
    v_add_f32 v12, v12, v16
    v_add_f32 v14, v14, v18
    v_and_b32 v5, s44, v5
    v_and_b32 v7, s44, v7
    v_and_b32 v9, s44, v9
    v_and_b32 v11, s44, v11
    v_and_b32 v13, s44, v13
    v_and_b32 v15, s44, v15
    v_and_b32 v17, s44, v17
    v_and_b32 v19, s44, v19
    v_add_f32 v4, v4, v12
    v_add_f32 v6, v6, v14
    v_max3_f32 v5, v5, v9, v13
    v_max3_f32 v7, v7, v11, v15
    v_max_f32 v5, v5, v17
    v_max_f32 v7, v7, v19
    v_permlane32_swap_b32 v4, v6
    v_add_f32 v4, v4, v6
    v_permlane32_swap_b32 v5, v7
    v_mov_b32 v6, v4
    v_max_f32 v5, v5, v7
    v_mov_b32 v7, v5
    v_permlane16_swap_b32 v4, v6
    v_add_f32 v4, v4, v6
    v_permlane16_swap_b32 v5, v7
    v_max_f32 v5, v5, v7
    v_add_f32_dpp v4, v4, v4 row_ror:8 row_mask:0xf bank_mask:0xf
    s_nop 0
    v_max_f32_dpp v5, v5, v5 row_ror:8 row_mask:0xf bank_mask:0xf
    v_or_b32 v5, v23, v5
    s_waitcnt lgkmcnt(0)
    v_readfirstlane_b32 s42, v26
    s_cmp_lg_u32 s42, 0
    s_cbranch_scc1 L_common
    buffer_store_dwordx2 v[4:5], v21, s[20:23], s48 offen sc1
    buffer_store_dwordx2 v[4:5], v22, s[20:23], s48 offen sc1
    ds_write_b32 v24, v25 offset:46080
    s_branch L_common
L_role4:
    s_sub_u32 s43, s36, 4
    s_cmp_ge_u32 s43, 3
    s_cbranch_scc1 L_common
    s_mul_i32 s42, s43, 6144
    s_add_u32 s42, s42, 46144
    v_add_u32 v38, s42, v36
    ds_write_b128 v38, v[144:147] offset:0
    ds_write_b128 v38, v[148:151] offset:1024
    ds_write_b128 v38, v[152:155] offset:2048
    ds_write_b128 v38, v[156:159] offset:3072
    ds_write_b128 v38, v[160:163] offset:4096
    ds_write_b128 v38, v[164:167] offset:5120
    v_lshrrev_b32 v2, 4, v35
    v_lshlrev_b32 v2, 3, v2
    v_bfe_u32 v3, v35, 2, 2
    v_add_u32 v2, v2, v3
    v_mul_u32_u24 v2, 96, v2
    v_and_b32 v3, 3, v35
    v_lshl_add_u32 v2, v3, 3, v2
    s_lshl_b32 s42, s43, 5
    v_add_u32 v2, s42, v2
    s_waitcnt lgkmcnt(0)
    ds_read_b64_tr_b16 v[144:145], v2 offset:0
    ds_read_b64_tr_b16 v[146:147], v2 offset:384
    ds_read_b64_tr_b16 v[148:149], v2 offset:3072
    ds_read_b64_tr_b16 v[150:151], v2 offset:3456
    ds_read_b64_tr_b16 v[152:153], v2 offset:6144
    ds_read_b64_tr_b16 v[154:155], v2 offset:6528
    ds_read_b64_tr_b16 v[156:157], v2 offset:9216
    ds_read_b64_tr_b16 v[158:159], v2 offset:9600
    ds_read_b64_tr_b16 v[160:161], v2 offset:12288
    ds_read_b64_tr_b16 v[162:163], v2 offset:12672
    ds_read_b64_tr_b16 v[164:165], v2 offset:15360
    ds_read_b64_tr_b16 v[166:167], v2 offset:15744
    v_and_b32 v2, 1, v35
    v_mul_u32_u24 v2, 384, v2
    v_lshrrev_b32 v3, 4, v35
    v_lshl_add_u32 v39, v3, 4, v2
    s_waitcnt lgkmcnt(0)
L_common:
    v_lshrrev_b32 v2, 5, v35
    v_bfe_u32 v3, v35, 3, 2
    v_mul_u32_u24 v3, 1536, v3
    v_lshl_add_u32 v8, v2, 14, v3
    v_and_b32 v3, 0x70, v36
    v_add_u32 v8, v8, v3
    s_add_u32 s42, s56, s2
    s_lshr_b32 s43, s57, 22
    s_xor_b32 s42, s42, s43
    s_and_b32 s42, s42, 4
    s_lshl_b32 s42, s42, 11
    s_and_b32 s43, s2, 7
    s_lshl_b32 s43, s43, 15
    s_add_u32 s42, s42, s43
    s_lshl_b32 s43, s36, 7
    s_add_u32 s47, s42, s43
    v_lshrrev_b32 v3, 2, v3
    v_lshl_add_u32 v9, v2, 1, v3
    s_lshl_b32 s42, s36, 5
    v_add_u32 v9, s42, v9
    v_lshrrev_b32 v2, 2, v35
    v_mul_u32_u24 v2, 384, v2
    v_and_b32 v3, 3, v35
    v_lshl_add_u32 v2, v3, 3, v2
    v_add_u32 v2, s42, v2
    ds_read_b64_tr_b16 v[28:29], v2 offset:18432
    ds_read_b64_tr_b16 v[30:31], v2 offset:24576
    ds_read_b64_tr_b16 v[32:33], v2 offset:30720
    v_lshlrev_b32 v37, 3, v35
    s_cmp_lt_u32 s36, 2
    s_cselect_b32 s3, 64, 0
    s_lshr_b32 s42, s2, 3
    s_sub_u32 s42, s42, 16
    s_cmp_ge_u32 s42, 12
    s_cbranch_scc1 L_open
    v_mov_b32 v2, 0
L_gate:
    ds_read_b32 v3, v2 offset:46080
    s_waitcnt lgkmcnt(0)
    v_cmp_ne_u32 vcc, 0, v3
    s_cbranch_vccnz L_open
    s_sub_u32 s3, s3, 1
    s_cmp_eq_u32 s3, 0
    s_cbranch_scc0 L_nowt0
    s_mov_b64 s[4:5], exec
    s_mov_b32 exec_lo, -1
    s_mov_b32 exec_hi, 0xffff
    buffer_store_dwordx4 v[18:21], v36, s[20:23], s48 offen sc1
    s_mov_b64 exec, s[4:5]
L_nowt0:
    s_add_u32 s45, s45, 1
    s_cmp_lt_u32 s45, 4194304
    s_cbranch_scc1 L_gate
    s_branch L_open
.p2align 12
L_open:
    buffer_load_dwordx4 v[4:7], v8, s[20:23], s47 offen sc1
L_pollB:
    s_waitcnt vmcnt(0)
    v_cmp_ne_u16 vcc, s46, v5
    v_cmp_ne_u16 s[4:5], s52, v7
    s_or_b64 vcc, vcc, s[4:5]
    s_cbranch_scc0 L_gotB
    s_wqm_b64 exec, vcc
    buffer_load_dwordx4 v[4:7], v8, s[20:23], s47 offen sc1
    s_sub_u32 s3, s3, 1
    s_cmp_eq_u32 s3, 0
    s_cbranch_scc0 L_nowt1
    s_mov_b64 s[4:5], exec
    s_mov_b32 exec_lo, -1
    s_mov_b32 exec_hi, 0xffff
    buffer_store_dwordx4 v[18:21], v36, s[20:23], s48 offen sc1
    s_mov_b64 exec, s[4:5]
L_nowt1:
    s_add_u32 s45, s45, 1
    s_cmp_lt_u32 s45, 4194304
    s_cbranch_scc1 L_pollB
    s_waitcnt vmcnt(0)
L_gotB:
    s_mov_b64 exec, -1
    v_and_b32 v5, s44, v5
    v_and_b32 v7, s44, v7
    v_permlane32_swap_b32 v4, v6
    v_add_f32 v4, v4, v6
    v_permlane32_swap_b32 v5, v7
    v_mov_b32 v6, v4
    v_max_f32 v5, v5, v7
    v_mov_b32 v7, v5
    v_permlane16_swap_b32 v4, v6
    v_add_f32 v4, v4, v6
    v_permlane16_swap_b32 v5, v7
    v_max_f32 v5, v5, v7
    v_add_f32_dpp v4, v4, v4 row_ror:8 row_mask:0xf bank_mask:0xf
    s_nop 0
    v_max_f32_dpp v5, v5, v5 row_ror:8 row_mask:0xf bank_mask:0xf
    v_mul_f32 v4, 0x36800000, v4
    v_cvt_pk_bf16_f32 v4, v4, v5
    ds_write_b16 v9, v4 offset:43008
    ds_write_b16_d16_hi v9, v4 offset:43392
    s_cmp_gt_i32 s3, 0
    s_cbranch_scc0 L_nowt2
    s_mov_b32 exec_hi, 0xffff
    buffer_store_dwordx4 v[18:21], v36, s[20:23], s48 offen sc1
    s_mov_b32 exec_hi, -1
L_nowt2:
    s_sub_u32 s42, s36, 4
    s_cmp_ge_u32 s42, 3
    s_waitcnt lgkmcnt(0)
    s_barrier
    s_cbranch_scc1 L_l2
    ds_read_b128 v[4:7], v39 offset:43008
    ds_read_b128 v[8:11], v39 offset:43072
    ds_read_b128 v[12:15], v39 offset:43136
    ds_read_b128 v[16:19], v39 offset:43200
    ds_read_b128 v[20:23], v39 offset:43264
    ds_read_b128 v[24:27], v39 offset:43328
    s_lshl_b32 s42, s42, 9
    v_add_u32 v36, s42, v37
    s_mov_b32 s43, 0x7f800000
    s_waitcnt lgkmcnt(5)
    v_mfma_f32_16x16x32_bf16 v[0:3], v[144:147], v[4:7], 0
    s_waitcnt lgkmcnt(4)
    v_mfma_f32_16x16x32_bf16 v[0:3], v[148:151], v[8:11], v[0:3]
    s_waitcnt lgkmcnt(3)
    v_mfma_f32_16x16x32_bf16 v[0:3], v[152:155], v[12:15], v[0:3]
    s_waitcnt lgkmcnt(2)
    v_mfma_f32_16x16x32_bf16 v[0:3], v[156:159], v[16:19], v[0:3]
    s_waitcnt lgkmcnt(1)
    v_mfma_f32_16x16x32_bf16 v[0:3], v[160:163], v[20:23], v[0:3]
    s_waitcnt lgkmcnt(0)
    v_mfma_f32_16x16x32_bf16 v[0:3], v[164:167], v[24:27], v[0:3]
    s_nop 7
    v_mul_f32_e64 v4, v0, s43 clamp
    v_mul_f32_e64 v5, v1, s43 clamp
    v_mul_f32_e64 v6, v2, s43 clamp
    v_mul_f32_e64 v7, v3, s43 clamp
    v_pk_mul_f32 v[0:1], v[0:1], v[4:5]
    v_pk_mul_f32 v[2:3], v[2:3], v[6:7]
    v_cvt_pk_bf16_f32 v4, v0, v1
    v_cvt_pk_bf16_f32 v5, v2, v3
    ds_write_b64 v36, v[4:5] offset:43776
L_l2:
    v_lshrrev_b32 v0, 3, v35
    v_mul_u32_u24 v0, 384, v0
    v_and_b32 v1, 7, v35
    v_lshl_add_u32 v0, v1, 4, v0
    v_add_u32 v0, s39, v0
    v_add_u32 v1, 12288, v0
    s_waitcnt lgkmcnt(0)
    s_barrier
    ds_read_b64 v[4:5], v37 offset:43776
    ds_read_b64 v[6:7], v37 offset:44288
    ds_read_b64 v[8:9], v37 offset:44800
    v_and_b32 v2, 15, v35
    s_lshl_b32 s42, s36, 6
    v_lshl_add_u32 v36, v2, 2, s42
    v_and_b32 v2, 7, v35
    s_lshl_b32 s42, s38, 8
    v_lshl_add_u32 v39, v2, 5, s42
    s_mov_b32 s43, 0xbfb8aa3b
    v_bfe_i32 v3, v35, 0, 1
    v_xor_b32 v3, 0xffff, v3
    s_waitcnt lgkmcnt(2)
    v_mfma_f32_16x16x16_bf16 v[12:15], v[4:5], v[28:29], 0
    s_waitcnt lgkmcnt(1)
    v_mfma_f32_16x16x16_bf16 v[12:15], v[6:7], v[30:31], v[12:15]
    s_waitcnt lgkmcnt(0)
    v_mfma_f32_16x16x16_bf16 v[12:15], v[8:9], v[32:33], v[12:15]
    s_nop 7
    v_cvt_pk_bf16_f32 v12, v12, v13
    v_lshlrev_b32 v13, 16, v12
    v_and_b32 v12, s44, v12
    v_add_f32 v12, v12, v13
    v_cvt_pk_bf16_f32 v12, 0, v12
    v_mul_f32 v12, s43, v12
    v_exp_f32 v12, v12
    s_nop 0
    v_add_f32 v12, 1.0, v12
    v_rcp_f32 v12, v12
    s_nop 0
    v_cvt_pk_bf16_f32 v12, v12, v12
    v_and_b32 v12, v3, v12
    ds_write_b32 v36, v12 offset:45312
    s_waitcnt lgkmcnt(0)
    s_barrier
    ds_read_b128 v[2:5], v39 offset:45312
    ds_read_b128 v[6:9], v39 offset:45328
    v_readlane_b32 s50, v34, 5
    s_nop 1
    v_add_u32 v28, s50, v0
    v_bfe_u32 v28, v28, 13, 1
    v_mad_u32_u24 v28, v28, s49, v0
    s_waitcnt lgkmcnt(0)
    v_dot2_f32_bf16 v10, v80, v2, 0
    v_dot2_f32_bf16 v11, v80, v3, 0
    v_dot2_f32_bf16 v12, v81, v4, 0
    v_dot2_f32_bf16 v13, v81, v5, 0
    v_dot2_f32_bf16 v14, v82, v6, 0
    v_dot2_f32_bf16 v15, v82, v7, 0
    v_dot2_f32_bf16 v16, v83, v8, 0
    v_dot2_f32_bf16 v17, v83, v9, 0
    v_cvt_pk_bf16_f32 v80, v10, v11
    v_cvt_pk_bf16_f32 v81, v12, v13
    v_cvt_pk_bf16_f32 v82, v14, v15
    v_cvt_pk_bf16_f32 v83, v16, v17
    buffer_store_dwordx4 v[80:83], v28, s[12:15], s85 offen sc1
    s_sub_u32 s42, s36, 4
    s_cmp_ge_u32 s42, 3
    s_cbranch_scc1 L_noreload
    ds_read_b128 v[144:147], v38 offset:0
    ds_read_b128 v[148:151], v38 offset:1024
    ds_read_b128 v[152:155], v38 offset:2048
    ds_read_b128 v[156:159], v38 offset:3072
    ds_read_b128 v[160:163], v38 offset:4096
    ds_read_b128 v[164:167], v38 offset:5120
L_noreload:
    v_dot2_f32_bf16 v18, v84, v2, 0
    v_dot2_f32_bf16 v19, v84, v3, 0
    v_dot2_f32_bf16 v20, v85, v4, 0
    v_dot2_f32_bf16 v21, v85, v5, 0
    v_dot2_f32_bf16 v22, v86, v6, 0
    v_dot2_f32_bf16 v23, v86, v7, 0
    v_dot2_f32_bf16 v24, v87, v8, 0
    v_dot2_f32_bf16 v25, v87, v9, 0
    v_add_u32 v29, s50, v1
    v_bfe_u32 v29, v29, 13, 1
    v_mad_u32_u24 v29, v29, s49, v1
    v_cvt_pk_bf16_f32 v84, v18, v19
    v_cvt_pk_bf16_f32 v85, v20, v21
    v_cvt_pk_bf16_f32 v86, v22, v23
    v_cvt_pk_bf16_f32 v87, v24, v25
    buffer_store_dwordx4 v[84:87], v29, s[12:15], s85 offen sc1
    s_barrier
    v_readlane_b32 s50, v34, 0
    v_dot2_f32_bf16 v10, v40, v2, 0
    v_dot2_f32_bf16 v11, v40, v3, 0
    v_dot2_f32_bf16 v12, v41, v4, 0
    v_dot2_f32_bf16 v13, v41, v5, 0
    v_dot2_f32_bf16 v14, v42, v6, 0
    v_dot2_f32_bf16 v15, v42, v7, 0
    v_dot2_f32_bf16 v16, v43, v8, 0
    v_dot2_f32_bf16 v17, v43, v9, 0
    v_add_u32 v26, s50, v0
    v_bfe_u32 v26, v26, 13, 1
    v_mad_u32_u24 v26, v26, s49, v0
    v_cvt_pk_bf16_f32 v40, v10, v11
    v_cvt_pk_bf16_f32 v41, v12, v13
    v_cvt_pk_bf16_f32 v42, v14, v15
    v_cvt_pk_bf16_f32 v43, v16, v17
    buffer_store_dwordx4 v[40:43], v26, s[12:15], s80 offen sc1
    v_dot2_f32_bf16 v18, v44, v2, 0
    v_dot2_f32_bf16 v19, v44, v3, 0
    v_dot2_f32_bf16 v20, v45, v4, 0
    v_dot2_f32_bf16 v21, v45, v5, 0
    v_dot2_f32_bf16 v22, v46, v6, 0
    v_dot2_f32_bf16 v23, v46, v7, 0
    v_dot2_f32_bf16 v24, v47, v8, 0
    v_dot2_f32_bf16 v25, v47, v9, 0
    v_add_u32 v27, s50, v1
    v_bfe_u32 v27, v27, 13, 1
    v_mad_u32_u24 v27, v27, s49, v1
    v_cvt_pk_bf16_f32 v44, v18, v19
    v_cvt_pk_bf16_f32 v45, v20, v21
    v_cvt_pk_bf16_f32 v46, v22, v23
    v_cvt_pk_bf16_f32 v47, v24, v25
    buffer_store_dwordx4 v[44:47], v27, s[12:15], s80 offen sc1
    s_barrier
    v_readlane_b32 s50, v34, 6
    v_dot2_f32_bf16 v10, v88, v2, 0
    v_dot2_f32_bf16 v11, v88, v3, 0
    v_dot2_f32_bf16 v12, v89, v4, 0
    v_dot2_f32_bf16 v13, v89, v5, 0
    v_dot2_f32_bf16 v14, v90, v6, 0
    v_dot2_f32_bf16 v15, v90, v7, 0
    v_dot2_f32_bf16 v16, v91, v8, 0
    v_dot2_f32_bf16 v17, v91, v9, 0
    v_add_u32 v28, s50, v0
    v_bfe_u32 v28, v28, 13, 1
    v_mad_u32_u24 v28, v28, s49, v0
    v_cvt_pk_bf16_f32 v88, v10, v11
    v_cvt_pk_bf16_f32 v89, v12, v13
    v_cvt_pk_bf16_f32 v90, v14, v15
    v_cvt_pk_bf16_f32 v91, v16, v17
    buffer_store_dwordx4 v[88:91], v28, s[12:15], s86 offen sc1
    v_dot2_f32_bf16 v18, v92, v2, 0
    v_dot2_f32_bf16 v19, v92, v3, 0
    v_dot2_f32_bf16 v20, v93, v4, 0
    v_dot2_f32_bf16 v21, v93, v5, 0
    v_dot2_f32_bf16 v22, v94, v6, 0
    v_dot2_f32_bf16 v23, v94, v7, 0
    v_dot2_f32_bf16 v24, v95, v8, 0
    v_dot2_f32_bf16 v25, v95, v9, 0
    v_add_u32 v29, s50, v1
    v_bfe_u32 v29, v29, 13, 1
    v_mad_u32_u24 v29, v29, s49, v1
    v_cvt_pk_bf16_f32 v92, v18, v19
    v_cvt_pk_bf16_f32 v93, v20, v21
    v_cvt_pk_bf16_f32 v94, v22, v23
    v_cvt_pk_bf16_f32 v95, v24, v25
    buffer_store_dwordx4 v[92:95], v29, s[12:15], s86 offen sc1
    s_barrier
    v_readlane_b32 s50, v34, 7
    v_dot2_f32_bf16 v10, v96, v2, 0
    v_dot2_f32_bf16 v11, v96, v3, 0
    v_dot2_f32_bf16 v12, v97, v4, 0
    v_dot2_f32_bf16 v13, v97, v5, 0
    v_dot2_f32_bf16 v14, v98, v6, 0
    v_dot2_f32_bf16 v15, v98, v7, 0
    v_dot2_f32_bf16 v16, v99, v8, 0
    v_dot2_f32_bf16 v17, v99, v9, 0
    v_add_u32 v28, s50, v0
    v_bfe_u32 v28, v28, 13, 1
    v_mad_u32_u24 v28, v28, s49, v0
    v_cvt_pk_bf16_f32 v96, v10, v11
    v_cvt_pk_bf16_f32 v97, v12, v13
    v_cvt_pk_bf16_f32 v98, v14, v15
    v_cvt_pk_bf16_f32 v99, v16, v17
    buffer_store_dwordx4 v[96:99], v28, s[12:15], s87 offen sc1
    v_dot2_f32_bf16 v18, v100, v2, 0
    v_dot2_f32_bf16 v19, v100, v3, 0
    v_dot2_f32_bf16 v20, v101, v4, 0
    v_dot2_f32_bf16 v21, v101, v5, 0
    v_dot2_f32_bf16 v22, v102, v6, 0
    v_dot2_f32_bf16 v23, v102, v7, 0
    v_dot2_f32_bf16 v24, v103, v8, 0
    v_dot2_f32_bf16 v25, v103, v9, 0
    v_add_u32 v29, s50, v1
    v_bfe_u32 v29, v29, 13, 1
    v_mad_u32_u24 v29, v29, s49, v1
    v_cvt_pk_bf16_f32 v100, v18, v19
    v_cvt_pk_bf16_f32 v101, v20, v21
    v_cvt_pk_bf16_f32 v102, v22, v23
    v_cvt_pk_bf16_f32 v103, v24, v25
    buffer_store_dwordx4 v[100:103], v29, s[12:15], s87 offen sc1
    s_barrier
    v_dot2_f32_bf16 v10, v48, v2, 0
    v_dot2_f32_bf16 v11, v48, v3, 0
    v_dot2_f32_bf16 v12, v49, v4, 0
    v_dot2_f32_bf16 v13, v49, v5, 0
    v_dot2_f32_bf16 v14, v50, v6, 0
    v_dot2_f32_bf16 v15, v50, v7, 0
    v_dot2_f32_bf16 v16, v51, v8, 0
    v_dot2_f32_bf16 v17, v51, v9, 0
    v_cvt_pk_bf16_f32 v48, v10, v11
    v_cvt_pk_bf16_f32 v49, v12, v13
    v_cvt_pk_bf16_f32 v50, v14, v15
    v_cvt_pk_bf16_f32 v51, v16, v17
    buffer_store_dwordx4 v[48:51], v26, s[12:15], s81 offen sc1
    v_dot2_f32_bf16 v18, v52, v2, 0
    v_dot2_f32_bf16 v19, v52, v3, 0
    v_dot2_f32_bf16 v20, v53, v4, 0
    v_dot2_f32_bf16 v21, v53, v5, 0
    v_dot2_f32_bf16 v22, v54, v6, 0
    v_dot2_f32_bf16 v23, v54, v7, 0
    v_dot2_f32_bf16 v24, v55, v8, 0
    v_dot2_f32_bf16 v25, v55, v9, 0
    v_cvt_pk_bf16_f32 v52, v18, v19
    v_cvt_pk_bf16_f32 v53, v20, v21
    v_cvt_pk_bf16_f32 v54, v22, v23
    v_cvt_pk_bf16_f32 v55, v24, v25
    buffer_store_dwordx4 v[52:55], v27, s[12:15], s81 offen sc1
    s_barrier
    v_readlane_b32 s50, v34, 8
    v_dot2_f32_bf16 v10, v104, v2, 0
    v_dot2_f32_bf16 v11, v104, v3, 0
    v_dot2_f32_bf16 v12, v105, v4, 0
    v_dot2_f32_bf16 v13, v105, v5, 0
    v_dot2_f32_bf16 v14, v106, v6, 0
    v_dot2_f32_bf16 v15, v106, v7, 0
    v_dot2_f32_bf16 v16, v107, v8, 0
    v_dot2_f32_bf16 v17, v107, v9, 0
    v_add_u32 v28, s50, v0
    v_bfe_u32 v28, v28, 13, 1
    v_mad_u32_u24 v28, v28, s49, v0
    v_cvt_pk_bf16_f32 v104, v10, v11
    v_cvt_pk_bf16_f32 v105, v12, v13
    v_cvt_pk_bf16_f32 v106, v14, v15
    v_cvt_pk_bf16_f32 v107, v16, v17
    buffer_store_dwordx4 v[104:107], v28, s[12:15], s88 offen sc1
    v_dot2_f32_bf16 v18, v108, v2, 0
    v_dot2_f32_bf16 v19, v108, v3, 0
    v_dot2_f32_bf16 v20, v109, v4, 0
    v_dot2_f32_bf16 v21, v109, v5, 0
    v_dot2_f32_bf16 v22, v110, v6, 0
    v_dot2_f32_bf16 v23, v110, v7, 0
    v_dot2_f32_bf16 v24, v111, v8, 0
    v_dot2_f32_bf16 v25, v111, v9, 0
    v_add_u32 v29, s50, v1
    v_bfe_u32 v29, v29, 13, 1
    v_mad_u32_u24 v29, v29, s49, v1
    v_cvt_pk_bf16_f32 v108, v18, v19
    v_cvt_pk_bf16_f32 v109, v20, v21
    v_cvt_pk_bf16_f32 v110, v22, v23
    v_cvt_pk_bf16_f32 v111, v24, v25
    buffer_store_dwordx4 v[108:111], v29, s[12:15], s88 offen sc1
    s_barrier
    v_readlane_b32 s50, v34, 9
    v_dot2_f32_bf16 v10, v112, v2, 0
    v_dot2_f32_bf16 v11, v112, v3, 0
    v_dot2_f32_bf16 v12, v113, v4, 0
    v_dot2_f32_bf16 v13, v113, v5, 0
    v_dot2_f32_bf16 v14, v114, v6, 0
    v_dot2_f32_bf16 v15, v114, v7, 0
    v_dot2_f32_bf16 v16, v115, v8, 0
    v_dot2_f32_bf16 v17, v115, v9, 0
    v_add_u32 v28, s50, v0
    v_bfe_u32 v28, v28, 13, 1
    v_mad_u32_u24 v28, v28, s49, v0
    v_cvt_pk_bf16_f32 v112, v10, v11
    v_cvt_pk_bf16_f32 v113, v12, v13
    v_cvt_pk_bf16_f32 v114, v14, v15
    v_cvt_pk_bf16_f32 v115, v16, v17
    buffer_store_dwordx4 v[112:115], v28, s[12:15], s89 offen sc1
    v_dot2_f32_bf16 v18, v116, v2, 0
    v_dot2_f32_bf16 v19, v116, v3, 0
    v_dot2_f32_bf16 v20, v117, v4, 0
    v_dot2_f32_bf16 v21, v117, v5, 0
    v_dot2_f32_bf16 v22, v118, v6, 0
    v_dot2_f32_bf16 v23, v118, v7, 0
    v_dot2_f32_bf16 v24, v119, v8, 0
    v_dot2_f32_bf16 v25, v119, v9, 0
    v_add_u32 v29, s50, v1
    v_bfe_u32 v29, v29, 13, 1
    v_mad_u32_u24 v29, v29, s49, v1
    v_cvt_pk_bf16_f32 v116, v18, v19
    v_cvt_pk_bf16_f32 v117, v20, v21
    v_cvt_pk_bf16_f32 v118, v22, v23
    v_cvt_pk_bf16_f32 v119, v24, v25
    buffer_store_dwordx4 v[116:119], v29, s[12:15], s89 offen sc1
    s_barrier
    v_dot2_f32_bf16 v10, v56, v2, 0
    v_dot2_f32_bf16 v11, v56, v3, 0
    v_dot2_f32_bf16 v12, v57, v4, 0
    v_dot2_f32_bf16 v13, v57, v5, 0
    v_dot2_f32_bf16 v14, v58, v6, 0
    v_dot2_f32_bf16 v15, v58, v7, 0
    v_dot2_f32_bf16 v16, v59, v8, 0
    v_dot2_f32_bf16 v17, v59, v9, 0
    v_cvt_pk_bf16_f32 v56, v10, v11
    v_cvt_pk_bf16_f32 v57, v12, v13
    v_cvt_pk_bf16_f32 v58, v14, v15
    v_cvt_pk_bf16_f32 v59, v16, v17
    buffer_store_dwordx4 v[56:59], v26, s[12:15], s82 offen sc1
    v_dot2_f32_bf16 v18, v60, v2, 0
    v_dot2_f32_bf16 v19, v60, v3, 0
    v_dot2_f32_bf16 v20, v61, v4, 0
    v_dot2_f32_bf16 v21, v61, v5, 0
    v_dot2_f32_bf16 v22, v62, v6, 0
    v_dot2_f32_bf16 v23, v62, v7, 0
    v_dot2_f32_bf16 v24, v63, v8, 0
    v_dot2_f32_bf16 v25, v63, v9, 0
    v_cvt_pk_bf16_f32 v60, v18, v19
    v_cvt_pk_bf16_f32 v61, v20, v21
    v_cvt_pk_bf16_f32 v62, v22, v23
    v_cvt_pk_bf16_f32 v63, v24, v25
    buffer_store_dwordx4 v[60:63], v27, s[12:15], s82 offen sc1
    s_barrier
    v_readlane_b32 s50, v34, 10
    v_dot2_f32_bf16 v10, v120, v2, 0
    v_dot2_f32_bf16 v11, v120, v3, 0
    v_dot2_f32_bf16 v12, v121, v4, 0
    v_dot2_f32_bf16 v13, v121, v5, 0
    v_dot2_f32_bf16 v14, v122, v6, 0
    v_dot2_f32_bf16 v15, v122, v7, 0
    v_dot2_f32_bf16 v16, v123, v8, 0
    v_dot2_f32_bf16 v17, v123, v9, 0
    v_add_u32 v28, s50, v0
    v_bfe_u32 v28, v28, 13, 1
    v_mad_u32_u24 v28, v28, s49, v0
    v_cvt_pk_bf16_f32 v120, v10, v11
    v_cvt_pk_bf16_f32 v121, v12, v13
    v_cvt_pk_bf16_f32 v122, v14, v15
    v_cvt_pk_bf16_f32 v123, v16, v17
    buffer_store_dwordx4 v[120:123], v28, s[12:15], s90 offen sc1
    v_dot2_f32_bf16 v18, v124, v2, 0
    v_dot2_f32_bf16 v19, v124, v3, 0
    v_dot2_f32_bf16 v20, v125, v4, 0
    v_dot2_f32_bf16 v21, v125, v5, 0
    v_dot2_f32_bf16 v22, v126, v6, 0
    v_dot2_f32_bf16 v23, v126, v7, 0
    v_dot2_f32_bf16 v24, v127, v8, 0
    v_dot2_f32_bf16 v25, v127, v9, 0
    v_add_u32 v29, s50, v1
    v_bfe_u32 v29, v29, 13, 1
    v_mad_u32_u24 v29, v29, s49, v1
    v_cvt_pk_bf16_f32 v124, v18, v19
    v_cvt_pk_bf16_f32 v125, v20, v21
    v_cvt_pk_bf16_f32 v126, v22, v23
    v_cvt_pk_bf16_f32 v127, v24, v25
    buffer_store_dwordx4 v[124:127], v29, s[12:15], s90 offen sc1
    s_barrier
    v_readlane_b32 s50, v34, 11
    v_dot2_f32_bf16 v10, v128, v2, 0
    v_dot2_f32_bf16 v11, v128, v3, 0
    v_dot2_f32_bf16 v12, v129, v4, 0
    v_dot2_f32_bf16 v13, v129, v5, 0
    v_dot2_f32_bf16 v14, v130, v6, 0
    v_dot2_f32_bf16 v15, v130, v7, 0
    v_dot2_f32_bf16 v16, v131, v8, 0
    v_dot2_f32_bf16 v17, v131, v9, 0
    v_add_u32 v28, s50, v0
    v_bfe_u32 v28, v28, 13, 1
    v_mad_u32_u24 v28, v28, s49, v0
    v_cvt_pk_bf16_f32 v128, v10, v11
    v_cvt_pk_bf16_f32 v129, v12, v13
    v_cvt_pk_bf16_f32 v130, v14, v15
    v_cvt_pk_bf16_f32 v131, v16, v17
    buffer_store_dwordx4 v[128:131], v28, s[12:15], s91 offen sc1
    v_dot2_f32_bf16 v18, v132, v2, 0
    v_dot2_f32_bf16 v19, v132, v3, 0
    v_dot2_f32_bf16 v20, v133, v4, 0
    v_dot2_f32_bf16 v21, v133, v5, 0
    v_dot2_f32_bf16 v22, v134, v6, 0
    v_dot2_f32_bf16 v23, v134, v7, 0
    v_dot2_f32_bf16 v24, v135, v8, 0
    v_dot2_f32_bf16 v25, v135, v9, 0
    v_add_u32 v29, s50, v1
    v_bfe_u32 v29, v29, 13, 1
    v_mad_u32_u24 v29, v29, s49, v1
    v_cvt_pk_bf16_f32 v132, v18, v19
    v_cvt_pk_bf16_f32 v133, v20, v21
    v_cvt_pk_bf16_f32 v134, v22, v23
    v_cvt_pk_bf16_f32 v135, v24, v25
    buffer_store_dwordx4 v[132:135], v29, s[12:15], s91 offen sc1
    s_barrier
    v_dot2_f32_bf16 v10, v64, v2, 0
    v_dot2_f32_bf16 v11, v64, v3, 0
    v_dot2_f32_bf16 v12, v65, v4, 0
    v_dot2_f32_bf16 v13, v65, v5, 0
    v_dot2_f32_bf16 v14, v66, v6, 0
    v_dot2_f32_bf16 v15, v66, v7, 0
    v_dot2_f32_bf16 v16, v67, v8, 0
    v_dot2_f32_bf16 v17, v67, v9, 0
    v_cvt_pk_bf16_f32 v64, v10, v11
    v_cvt_pk_bf16_f32 v65, v12, v13
    v_cvt_pk_bf16_f32 v66, v14, v15
    v_cvt_pk_bf16_f32 v67, v16, v17
    buffer_store_dwordx4 v[64:67], v26, s[12:15], s83 offen sc1
    v_dot2_f32_bf16 v18, v68, v2, 0
    v_dot2_f32_bf16 v19, v68, v3, 0
    v_dot2_f32_bf16 v20, v69, v4, 0
    v_dot2_f32_bf16 v21, v69, v5, 0
    v_dot2_f32_bf16 v22, v70, v6, 0
    v_dot2_f32_bf16 v23, v70, v7, 0
    v_dot2_f32_bf16 v24, v71, v8, 0
    v_dot2_f32_bf16 v25, v71, v9, 0
    v_cvt_pk_bf16_f32 v68, v18, v19
    v_cvt_pk_bf16_f32 v69, v20, v21
    v_cvt_pk_bf16_f32 v70, v22, v23
    v_cvt_pk_bf16_f32 v71, v24, v25
    buffer_store_dwordx4 v[68:71], v27, s[12:15], s83 offen sc1
    s_branch L_pageW22
.p2align 12
L_pageW22:
    s_barrier
    v_readlane_b32 s50, v34, 12
    v_dot2_f32_bf16 v10, v136, v2, 0
    v_dot2_f32_bf16 v11, v136, v3, 0
    v_dot2_f32_bf16 v12, v137, v4, 0
    v_dot2_f32_bf16 v13, v137, v5, 0
    v_dot2_f32_bf16 v14, v138, v6, 0
    v_dot2_f32_bf16 v15, v138, v7, 0
    v_dot2_f32_bf16 v16, v139, v8, 0
    v_dot2_f32_bf16 v17, v139, v9, 0
    v_add_u32 v28, s50, v0
    v_bfe_u32 v28, v28, 13, 1
    v_mad_u32_u24 v28, v28, s49, v0
    v_cvt_pk_bf16_f32 v136, v10, v11
    v_cvt_pk_bf16_f32 v137, v12, v13
    v_cvt_pk_bf16_f32 v138, v14, v15
    v_cvt_pk_bf16_f32 v139, v16, v17
    buffer_store_dwordx4 v[136:139], v28, s[12:15], s92 offen sc1
    v_dot2_f32_bf16 v18, v140, v2, 0
    v_dot2_f32_bf16 v19, v140, v3, 0
    v_dot2_f32_bf16 v20, v141, v4, 0
    v_dot2_f32_bf16 v21, v141, v5, 0
    v_dot2_f32_bf16 v22, v142, v6, 0
    v_dot2_f32_bf16 v23, v142, v7, 0
    v_dot2_f32_bf16 v24, v143, v8, 0
    v_dot2_f32_bf16 v25, v143, v9, 0
    v_add_u32 v29, s50, v1
    v_bfe_u32 v29, v29, 13, 1
    v_mad_u32_u24 v29, v29, s49, v1
    v_cvt_pk_bf16_f32 v140, v18, v19
    v_cvt_pk_bf16_f32 v141, v20, v21
    v_cvt_pk_bf16_f32 v142, v22, v23
    v_cvt_pk_bf16_f32 v143, v24, v25
    buffer_store_dwordx4 v[140:143], v29, s[12:15], s92 offen sc1
    s_waitcnt lgkmcnt(0)
    s_barrier
    v_readlane_b32 s50, v34, 13
    v_dot2_f32_bf16 v10, v144, v2, 0
    v_dot2_f32_bf16 v11, v144, v3, 0
    v_dot2_f32_bf16 v12, v145, v4, 0
    v_dot2_f32_bf16 v13, v145, v5, 0
    v_dot2_f32_bf16 v14, v146, v6, 0
    v_dot2_f32_bf16 v15, v146, v7, 0
    v_dot2_f32_bf16 v16, v147, v8, 0
    v_dot2_f32_bf16 v17, v147, v9, 0
    v_add_u32 v28, s50, v0
    v_bfe_u32 v28, v28, 13, 1
    v_mad_u32_u24 v28, v28, s49, v0
    v_cvt_pk_bf16_f32 v144, v10, v11
    v_cvt_pk_bf16_f32 v145, v12, v13
    v_cvt_pk_bf16_f32 v146, v14, v15
    v_cvt_pk_bf16_f32 v147, v16, v17
    buffer_store_dwordx4 v[144:147], v28, s[12:15], s93 offen sc1
    v_dot2_f32_bf16 v18, v148, v2, 0
    v_dot2_f32_bf16 v19, v148, v3, 0
    v_dot2_f32_bf16 v20, v149, v4, 0
    v_dot2_f32_bf16 v21, v149, v5, 0
    v_dot2_f32_bf16 v22, v150, v6, 0
    v_dot2_f32_bf16 v23, v150, v7, 0
    v_dot2_f32_bf16 v24, v151, v8, 0
    v_dot2_f32_bf16 v25, v151, v9, 0
    v_add_u32 v29, s50, v1
    v_bfe_u32 v29, v29, 13, 1
    v_mad_u32_u24 v29, v29, s49, v1
    v_cvt_pk_bf16_f32 v148, v18, v19
    v_cvt_pk_bf16_f32 v149, v20, v21
    v_cvt_pk_bf16_f32 v150, v22, v23
    v_cvt_pk_bf16_f32 v151, v24, v25
    buffer_store_dwordx4 v[148:151], v29, s[12:15], s93 offen sc1
    s_barrier
    v_dot2_f32_bf16 v10, v72, v2, 0
    v_dot2_f32_bf16 v11, v72, v3, 0
    v_dot2_f32_bf16 v12, v73, v4, 0
    v_dot2_f32_bf16 v13, v73, v5, 0
    v_dot2_f32_bf16 v14, v74, v6, 0
    v_dot2_f32_bf16 v15, v74, v7, 0
    v_dot2_f32_bf16 v16, v75, v8, 0
    v_dot2_f32_bf16 v17, v75, v9, 0
    v_cvt_pk_bf16_f32 v72, v10, v11
    v_cvt_pk_bf16_f32 v73, v12, v13
    v_cvt_pk_bf16_f32 v74, v14, v15
    v_cvt_pk_bf16_f32 v75, v16, v17
    buffer_store_dwordx4 v[72:75], v26, s[12:15], s84 offen sc1
    v_dot2_f32_bf16 v18, v76, v2, 0
    v_dot2_f32_bf16 v19, v76, v3, 0
    v_dot2_f32_bf16 v20, v77, v4, 0
    v_dot2_f32_bf16 v21, v77, v5, 0
    v_dot2_f32_bf16 v22, v78, v6, 0
    v_dot2_f32_bf16 v23, v78, v7, 0
    v_dot2_f32_bf16 v24, v79, v8, 0
    v_dot2_f32_bf16 v25, v79, v9, 0
    v_cvt_pk_bf16_f32 v76, v18, v19
    v_cvt_pk_bf16_f32 v77, v20, v21
    v_cvt_pk_bf16_f32 v78, v22, v23
    v_cvt_pk_bf16_f32 v79, v24, v25
    buffer_store_dwordx4 v[76:79], v27, s[12:15], s84 offen sc1
    s_barrier
    v_readlane_b32 s50, v34, 14
    v_dot2_f32_bf16 v10, v152, v2, 0
    v_dot2_f32_bf16 v11, v152, v3, 0
    v_dot2_f32_bf16 v12, v153, v4, 0
    v_dot2_f32_bf16 v13, v153, v5, 0
    v_dot2_f32_bf16 v14, v154, v6, 0
    v_dot2_f32_bf16 v15, v154, v7, 0
    v_dot2_f32_bf16 v16, v155, v8, 0
    v_dot2_f32_bf16 v17, v155, v9, 0
    v_add_u32 v28, s50, v0
    v_bfe_u32 v28, v28, 13, 1
    v_mad_u32_u24 v28, v28, s49, v0
    v_cvt_pk_bf16_f32 v152, v10, v11
    v_cvt_pk_bf16_f32 v153, v12, v13
    v_cvt_pk_bf16_f32 v154, v14, v15
    v_cvt_pk_bf16_f32 v155, v16, v17
    buffer_store_dwordx4 v[152:155], v28, s[12:15], s94 offen sc1
    v_dot2_f32_bf16 v18, v156, v2, 0
    v_dot2_f32_bf16 v19, v156, v3, 0
    v_dot2_f32_bf16 v20, v157, v4, 0
    v_dot2_f32_bf16 v21, v157, v5, 0
    v_dot2_f32_bf16 v22, v158, v6, 0
    v_dot2_f32_bf16 v23, v158, v7, 0
    v_dot2_f32_bf16 v24, v159, v8, 0
    v_dot2_f32_bf16 v25, v159, v9, 0
    v_add_u32 v29, s50, v1
    v_bfe_u32 v29, v29, 13, 1
    v_mad_u32_u24 v29, v29, s49, v1
    v_cvt_pk_bf16_f32 v156, v18, v19
    v_cvt_pk_bf16_f32 v157, v20, v21
    v_cvt_pk_bf16_f32 v158, v22, v23
    v_cvt_pk_bf16_f32 v159, v24, v25
    buffer_store_dwordx4 v[156:159], v29, s[12:15], s94 offen sc1
    s_barrier
    v_readlane_b32 s50, v34, 15
    v_dot2_f32_bf16 v10, v160, v2, 0
    v_dot2_f32_bf16 v11, v160, v3, 0
    v_dot2_f32_bf16 v12, v161, v4, 0
    v_dot2_f32_bf16 v13, v161, v5, 0
    v_dot2_f32_bf16 v14, v162, v6, 0
    v_dot2_f32_bf16 v15, v162, v7, 0
    v_dot2_f32_bf16 v16, v163, v8, 0
    v_dot2_f32_bf16 v17, v163, v9, 0
    v_add_u32 v28, s50, v0
    v_bfe_u32 v28, v28, 13, 1
    v_mad_u32_u24 v28, v28, s49, v0
    v_cvt_pk_bf16_f32 v160, v10, v11
    v_cvt_pk_bf16_f32 v161, v12, v13
    v_cvt_pk_bf16_f32 v162, v14, v15
    v_cvt_pk_bf16_f32 v163, v16, v17
    buffer_store_dwordx4 v[160:163], v28, s[12:15], s95 offen sc1
    v_dot2_f32_bf16 v18, v164, v2, 0
    v_dot2_f32_bf16 v19, v164, v3, 0
    v_dot2_f32_bf16 v20, v165, v4, 0
    v_dot2_f32_bf16 v21, v165, v5, 0
    v_dot2_f32_bf16 v22, v166, v6, 0
    v_dot2_f32_bf16 v23, v166, v7, 0
    v_dot2_f32_bf16 v24, v167, v8, 0
    v_dot2_f32_bf16 v25, v167, v9, 0
    v_add_u32 v29, s50, v1
    v_bfe_u32 v29, v29, 13, 1
    v_mad_u32_u24 v29, v29, s49, v1
    v_cvt_pk_bf16_f32 v164, v18, v19
    v_cvt_pk_bf16_f32 v165, v20, v21
    v_cvt_pk_bf16_f32 v166, v22, v23
    v_cvt_pk_bf16_f32 v167, v24, v25
    buffer_store_dwordx4 v[164:167], v29, s[12:15], s95 offen sc1
L_end:
    s_endpgm
.section .rodata,"a"
.p2align 6
.amdhsa_kernel standalone__channel_attn_cbam__vision_kernel
  .amdhsa_next_free_vgpr 168
  .amdhsa_next_free_sgpr 96
  .amdhsa_accum_offset 168
  .amdhsa_group_segment_fixed_size 0
  .amdhsa_kernarg_size 48
  .amdhsa_user_sgpr_count 2
  .amdhsa_user_sgpr_kernarg_segment_ptr 1
  .amdhsa_system_sgpr_workgroup_id_x 1
  .amdhsa_float_denorm_mode_32 3
.end_amdhsa_kernel
```
